```python
import torch

def _softmax(x, axis=-1):
    return torch.softmax(x, dim=axis)
def _gelu(x):
    return torch.nn.functional.gelu(x, approximate="tanh")
def _silu(x):
    return torch.nn.functional.silu(x)
def _sigmoid(x):
    return torch.sigmoid(x)
def _layernorm(x, axis=-1, eps=1e-5):
    m = x.mean(dim=axis, keepdim=True)
    v = x.var(dim=axis, keepdim=True, unbiased=False)
    return (x - m) / torch.sqrt(v + eps)
def _scatter_add(tgt, idx, src, axis=0):
    return tgt.clone().index_add_(axis, idx, src)
def _segment_sum(src, seg, n):
    out = torch.zeros((n,) + src.shape[1:], dtype=src.dtype)
    return out.index_add_(0, seg, src)
def _pad(x, pw):
    flat = tuple(v for pair in reversed(pw) for v in pair)
    return torch.nn.functional.pad(x, flat)

kernel_name = 'gated_mix__ssm_conv_s4__dense_activation_relu__prompt'

def setup_inputs():

    _w = (lambda a: (lambda t: t.to(torch.bfloat16) if t.is_floating_point() else t)(torch.as_tensor(a)))
    def _A_setup():
        B, L, D, N = 1, 2048, 640, 192
        A_re = -(lambda _x: torch.exp(torch.as_tensor(_x)))((lambda *s: torch.randn(*s, dtype=torch.bfloat16) * 6.4)(D, N))
        A_im = torch.pi * (lambda *s: torch.randn(*s, dtype=torch.bfloat16) * 0.1)(D, N)
        B_re = (lambda *s: torch.randn(*s, dtype=torch.bfloat16) * 0.2)(D, N)
        B_im = (lambda *s: torch.randn(*s, dtype=torch.bfloat16) * 0.2)(D, N)
        C_re = (lambda *s: torch.randn(*s, dtype=torch.bfloat16) * 0.2)(D, N)
        C_im = (lambda *s: torch.randn(*s, dtype=torch.bfloat16) * 0.2)(D, N)
        log_dt = (lambda *s: torch.randn(*s, dtype=torch.bfloat16) * 0.1)(D) * 0.5 - 4.0
        Dskip = (lambda *s: torch.randn(*s, dtype=torch.bfloat16) * 0.1)(D)
        return {
            "u": _w((lambda *s: torch.randn(*s, dtype=torch.bfloat16) * 0.05)(B, L, D)),
            "A_re": _w(A_re),
            "A_im": _w(A_im),
            "B_re": _w(B_re),
            "B_im": _w(B_im),
            "C_re": _w(C_re),
            "C_im": _w(C_im),
            "log_dt": _w(log_dt),
            "Dskip": _w(Dskip),
        }
    _A_in = _A_setup()

    def _B_setup():
        B, S, D, Dff = 1, 2048, 640, 1536
        return {
            "x": _w((lambda *s: torch.randn(*s, dtype=torch.bfloat16) * 0.05)(B, S, D)),
            "w1": _w((lambda *s: torch.randn(*s, dtype=torch.bfloat16) * 0.05)(D, Dff)),
            "w2": _w((lambda *s: torch.randn(*s, dtype=torch.bfloat16) * 0.05)(Dff, D)),
        }
    _B_in = _B_setup()

    return {
        "A_u": _A_in["u"],
        "A_A_re": _A_in["A_re"],
        "A_A_im": _A_in["A_im"],
        "A_B_re": _A_in["B_re"],
        "A_B_im": _A_in["B_im"],
        "A_C_re": _A_in["C_re"],
        "A_C_im": _A_in["C_im"],
        "A_log_dt": _A_in["log_dt"],
        "A_Dskip": _A_in["Dskip"],
        "B_x": _B_in["x"],
        "B_w1": _B_in["w1"],
        "B_w2": _B_in["w2"],
        "gate_w": _w((lambda *s: torch.randn(*s, dtype=torch.bfloat16) * 0.05)(640) * 16.0),
    }

def reference(A_u, A_A_re, A_A_im, A_B_re, A_B_im, A_C_re, A_C_im, A_log_dt, A_Dskip, B_x, B_w1, B_w2, gate_w):
    def _A_ref(u, A_re, A_im, B_re, B_im, C_re, C_im, log_dt, Dskip):
        Bsz, L, D = u.shape
        dt = torch.exp(log_dt)[:, None]
        A = A_re + 1j * A_im
        Bc = B_re + 1j * B_im
        Cc = C_re + 1j * C_im
        logdA = dt * A
        dB = dt * Bc
        l = (lambda x, dt: x.to(dt))(torch.arange(L), A_re.dtype)
        P = torch.exp(logdA[:, :, None] * l[None, None, :])
        K = torch.einsum("dn,dnl,dn->dl", Cc, P, dB).real
        L2 = 2 * L
        Kp = _pad(K, ((0, 0), (0, L)))
        up = (lambda x, *d: x.permute(*d))(u, 0, 2, 1)
        up = _pad(up, ((0, 0), (0, 0), (0, L)))
        Kf = (lambda x, axes=(-2,-1): torch.fft.rfft2(x.float(), dim=axes))(Kp[:, None, :], axes=(-2, -1))
        Uf = (lambda x, axes=(-2,-1): torch.fft.rfft2(x.float(), dim=axes))(up[:, :, None, :], axes=(-2, -1))
        Yf = Uf * Kf[None, :, :, :]
        y = (lambda x, s, axes=(-2,-1): torch.fft.irfft2(x, s=s, dim=axes).to(torch.bfloat16))(Yf, (1, L2), axes=(-2, -1))[:, :, 0, :L]
        y = (lambda x, *d: x.permute(*d))(y, 0, 2, 1) + u * Dskip[None, None, :]
        return y

    def _B_ref(x, w1, w2):
        h = torch.einsum("bsd,df->bsf", x, w1)
        zero = torch.zeros_like(h)
        h = torch.maximum(h, zero)
        return torch.einsum("bsf,fd->bsd", h, w2)

    x = A_u
    g = _sigmoid((x * gate_w).sum(-1, keepdims=True))
    a = _A_ref(x, A_A_re, A_A_im, A_B_re, A_B_im, A_C_re, A_C_im, A_log_dt, A_Dskip)
    b = _B_ref(x, B_w1, B_w2)
    return g * a + (1 - g) * b
```

```asm
; @launch grid=(256,1,1) block=(512,1,1) lds=163840
.amdgcn_target "amdgcn-amd-amdhsa--gfx950"
.text
.globl gated_mix__ssm_conv_s4__dense_activation_relu__prompt_kernel
.p2align 8
.type gated_mix__ssm_conv_s4__dense_activation_relu__prompt_kernel,@function
gated_mix__ssm_conv_s4__dense_activation_relu__prompt_kernel:
    s_load_dwordx16 s[16:31], s[0:1], 0
    s_load_dwordx16 s[32:47], s[0:1], 64
    s_cmpk_ge_u32 s2, 0x100
    s_cbranch_scc1 L_END
    v_lshrrev_b32 v1, 6, v0
    s_and_b32 s4, s2, 7
    v_readfirstlane_b32 s3, v1
    s_lshr_b32 s5, s2, 3
    v_and_b32 v1, 63, v0
    s_cmp_ge_u32 s5, 22
    s_cbranch_scc1 L_CONV
    s_mul_i32 s6, s5, 52
    s_lshr_b32 s6, s6, 8
    s_mul_i32 s7, s6, 5
    s_sub_u32 s7, s5, s7
    s_and_b32 s8, s4, 1
    s_lshl1_add_u32 s11, s7, s8
    s_and_b32 s8, s4, 6
    s_lshl1_add_u32 s10, s8, s6
    s_lshl1_add_u32 s8, s4, s7
    s_cmp_ge_u32 s5, 20
    s_cselect_b32 s10, s8, s10
    s_mul_i32 s9, s11, 5
    s_min_u32 s9, s9, 43
    s_cmp_ge_u32 s5, 20
    s_cbranch_scc1 L_GATE
    s_cmp_ge_u32 s3, 4
    s_cbranch_scc1 L_G1L
    s_mul_i32 s12, s4, 5
    s_lshr_b32 s12, s12, 2
    s_and_b32 s13, s3, 1
    s_add_u32 s12, s12, s13
    s_cmp_ge_u32 s12, 8
    s_cselect_b32 s15, -8, 2
    s_lshl_b32 s13, s12, 2
    s_add_u32 s13, s13, s6
    s_mul_i32 s13, s13, 49152
    s_lshr_b32 s14, s9, 1
    s_lshl_b32 s14, s14, 7
    s_add_u32 s13, s13, s14
    v_and_b32 v2, 15, v1
    v_lshrrev_b32 v3, 4, v1
    v_mul_u32_u24 v2, 3072, v2
    v_min_u32 v3, 2, v3
    v_lshl_add_u32 v2, v3, 7, v2
    s_mul_i32 s7, s7, 26
    v_min_u32 v3, 25, v1
    v_add_u32 v3, s7, v3
    v_min_u32 v3, 127, v3
    s_mul_i32 s14, s10, 163840
    s_lshl_b32 s12, s12, 7
    s_add_u32 s14, s14, s12
    v_mul_u32_u24 v3, 1280, v3
    s_cmp_ge_u32 s3, 2
    s_cselect_b64 vcc, -1, 0
    s_cselect_b32 s13, s14, s13
    v_cndmask_b32 v2, v2, v3, vcc
    v_add_u32 v40, s13, v2
    s_mov_b32 s81, 196608
    s_cselect_b32 s81, 128, s81
    s_mul_i32 s14, s81, s15
    v_add_u32 v3, s14, v40
    s_waitcnt lgkmcnt(0)
    s_cselect_b64 s[12:13], s[16:17], s[36:37]
    global_load_dword v36, v40, s[12:13]
    global_load_dword v36, v3, s[12:13]
    s_branch L_G1C
L_G1L:
    s_sub_u32 s12, s3, 4
    v_lshrrev_b32 v12, 3, v1
    s_lshl_b32 s6, s10, 7
    s_lshl_b32 s7, s12, 5
    s_add_u32 s6, s6, s7
    v_add_u32 v12, s6, v12
    s_movk_i32 s6, 1280
    v_mul_u32_u24 v12, s6, v12
    v_lshrrev_b32 v13, 4, v1
    v_xor_b32 v13, v13, v1
    v_and_b32 v13, 7, v13
    v_lshl_add_u32 v2, v13, 4, v12
    v_xor_b32 v3, 64, v2
    v_add_u32 v3, 9216, v3
    v_add_u32 v4, 18432, v2
    v_add_u32 v5, 18432, v3
    s_mul_i32 s6, s12, 320
    s_lshl_b32 s84, s9, 6
    s_mov_b32 s14, 52429
    s_movk_i32 s15, 3072
    v_add_u32 v11, s6, v1
    v_mul_u32_u24 v13, s14, v11
    v_lshrrev_b32 v13, 20, v13
    v_mul_u32_u24 v14, 20, v13
    v_sub_u32 v12, v11, v14
    v_bfe_u32 v14, v13, 3, 1
    v_lshlrev_b32 v14, 1, v14
    v_xor_b32 v12, v12, v14
    v_mul_u32_u24 v13, s15, v13
    v_lshl_add_u32 v6, v12, 4, v13
    v_add_u32 v11, 64, v11
    v_mul_u32_u24 v13, s14, v11
    v_lshrrev_b32 v13, 20, v13
    v_mul_u32_u24 v14, 20, v13
    v_sub_u32 v12, v11, v14
    v_bfe_u32 v14, v13, 3, 1
    v_lshlrev_b32 v14, 1, v14
    v_xor_b32 v12, v12, v14
    v_mul_u32_u24 v13, s15, v13
    v_lshl_add_u32 v7, v12, 4, v13
    v_subrev_u32 v7, 1024, v7
    v_add_u32 v11, 64, v11
    v_mul_u32_u24 v13, s14, v11
    v_lshrrev_b32 v13, 20, v13
    v_mul_u32_u24 v14, 20, v13
    v_sub_u32 v12, v11, v14
    v_bfe_u32 v14, v13, 3, 1
    v_lshlrev_b32 v14, 1, v14
    v_xor_b32 v12, v12, v14
    v_mul_u32_u24 v13, s15, v13
    v_lshl_add_u32 v8, v12, 4, v13
    v_subrev_u32 v8, 2048, v8
    v_add_u32 v11, 64, v11
    v_mul_u32_u24 v13, s14, v11
    v_lshrrev_b32 v13, 20, v13
    v_mul_u32_u24 v14, 20, v13
    v_sub_u32 v12, v11, v14
    v_bfe_u32 v14, v13, 3, 1
    v_lshlrev_b32 v14, 1, v14
    v_xor_b32 v12, v12, v14
    v_mul_u32_u24 v13, s15, v13
    v_lshl_add_u32 v9, v12, 4, v13
    v_subrev_u32 v9, 3072, v9
    v_add_u32 v11, 64, v11
    v_mul_u32_u24 v13, s14, v11
    v_lshrrev_b32 v13, 20, v13
    v_mul_u32_u24 v14, 20, v13
    v_sub_u32 v12, v11, v14
    v_bfe_u32 v14, v13, 3, 1
    v_lshlrev_b32 v14, 1, v14
    v_xor_b32 v12, v12, v14
    v_mul_u32_u24 v13, s15, v13
    v_lshl_add_u32 v10, v12, 4, v13
    s_mul_i32 s85, s4, 5
    s_lshr_b32 s85, s85, 2
    s_lshl_b32 s14, s85, 7
    s_mul_i32 s15, s85, 196608
    s_add_u32 s15, s15, s84
    s_lshl_b32 s13, s12, 12
    s_mul_i32 s80, s12, 5120
    s_add_u32 s80, s80, 16384
    s_waitcnt lgkmcnt(0)
    s_mov_b32 s48, s16
    s_mov_b32 s49, s17
    s_mov_b32 s50, 0x280000
    s_mov_b32 s51, 0x20000
    s_mov_b32 s52, s36
    s_mov_b32 s53, s37
    s_mov_b32 s54, 0x1e0000
    s_mov_b32 s55, 0x20000
    s_mov_b32 m0, s13
    s_nop 0
    buffer_load_dwordx4 v2, s[48:51], s14 offen offset:0 lds
    buffer_load_dwordx4 v3, s[48:51], s14 offen offset:1024 lds
    buffer_load_dwordx4 v4, s[48:51], s14 offen offset:2048 lds
    buffer_load_dwordx4 v5, s[48:51], s14 offen offset:3072 lds
    s_add_u32 m0, s80, 0
    s_nop 0
    buffer_load_dwordx4 v6, s[52:55], s15 offen offset:0 lds
    buffer_load_dwordx4 v7, s[52:55], s15 offen offset:1024 lds
    buffer_load_dwordx4 v8, s[52:55], s15 offen offset:2048 lds
    buffer_load_dwordx4 v9, s[52:55], s15 offen offset:3072 lds
    s_add_u32 m0, s80, 4096
    s_nop 0
    buffer_load_dwordx4 v10, s[52:55], s15 offen lds
    s_add_u32 m0, s13, 36864
    s_add_u32 s14, s14, 128
    s_add_u32 s15, s15, 196608
    s_cmp_eq_u32 s14, 1280
    s_cselect_b32 s14, 0, s14
    s_cselect_b32 s15, s84, s15
    buffer_load_dwordx4 v2, s[48:51], s14 offen offset:0 lds
    buffer_load_dwordx4 v3, s[48:51], s14 offen offset:1024 lds
    buffer_load_dwordx4 v4, s[48:51], s14 offen offset:2048 lds
    buffer_load_dwordx4 v5, s[48:51], s14 offen offset:3072 lds
    s_add_u32 m0, s80, 36864
    s_nop 0
    buffer_load_dwordx4 v6, s[52:55], s15 offen offset:0 lds
    buffer_load_dwordx4 v7, s[52:55], s15 offen offset:1024 lds
    buffer_load_dwordx4 v8, s[52:55], s15 offen offset:2048 lds
    buffer_load_dwordx4 v9, s[52:55], s15 offen offset:3072 lds
    s_add_u32 m0, s80, 40960
    s_nop 0
    buffer_load_dwordx4 v10, s[52:55], s15 offen lds
    v_lshrrev_b32 v11, 3, v1
    v_bfe_u32 v12, v1, 4, 2
    v_lshlrev_b32 v12, 1, v12
    s_movk_i32 s6, 1280
    v_mul_u32_u24 v11, s6, v11
    v_xor_b32 v12, v12, v1
    v_and_b32 v12, 7, v12
    v_lshl_add_u32 v11, v12, 4, v11
    s_lshl_b32 s6, s11, 7
    v_add_u32 v11, s6, v11
    s_mov_b32 s56, s38
    s_mov_b32 s57, s39
    s_mov_b32 s58, 0x1e0000
    s_mov_b32 s59, 0x20000
    s_mov_b32 s60, s46
    s_mov_b32 s61, s47
    s_mov_b32 s62, 0x600000
    s_mov_b32 s63, 0x20000
    s_add_u32 s68, s46, 0x880000
    s_addc_u32 s69, s47, 0
    s_mov_b32 s70, 0x10000
    s_mov_b32 s71, 0x20000
    s_add_u32 s64, s46, 0x600000
    s_addc_u32 s65, s47, 0
    s_mov_b32 s66, 0x280000
    s_mov_b32 s67, 0x20000
    s_mov_b32 s72, s42
    s_mov_b32 s73, s43
    s_mov_b32 s74, 0x280000
    s_mov_b32 s75, 0x20000
    s_lshl_b32 s81, s9, 2
    s_add_u32 s81, s81, s12
    s_mul_i32 s81, s81, 10240
    s_mul_i32 s82, s12, 10240
    s_add_u32 s82, s82, 1966080
    s_lshl_b32 s83, s12, 10
    v_lshrrev_b32 v12, 2, v1
    v_bfe_u32 v16, v1, 3, 2
    v_lshlrev_b32 v12, 7, v12
    v_lshl_or_b32 v12, v16, 5, v12
    v_and_b32 v16, 3, v1
    v_lshl_or_b32 v12, v16, 3, v12
    v_add_u32 v12, 147456, v12
    v_xor_b32 v13, 32, v12
    v_xor_b32 v14, 64, v12
    v_xor_b32 v15, 96, v12
    s_and_b32 s19, s3, 3
    s_lshl_b32 s6, s10, 3
    s_lshl_b32 s7, s19, 1
    s_add_u32 s16, s6, s7
    s_mul_i32 s6, s16, 49152
    v_lshl_add_u32 v60, v1, 4, s6
    v_add_u32 v61, 49152, v60
    s_lshl_b32 s7, s9, 3
    s_add_u32 s7, s7, 40
    v_min_u32 v59, 39, v1
    v_add_u32 v59, s7, v59
    v_subrev_u32 v58, 384, v59
    v_min_u32 v59, v59, v58
    v_lshl_add_u32 v59, v59, 7, s6
    s_add_u32 s17, s9, 10
    s_cmp_ge_u32 s17, 48
    s_cselect_b32 s6, 48, 0
    s_sub_u32 s17, s17, s6
    s_lshl_b32 s17, s17, 10
    s_lshl_b32 s6, s10, 2
    s_add_u32 s6, s6, s19
    s_mul_i32 s6, s6, 10
    s_add_u32 s6, s6, s11
    s_mul_i32 s6, s6, 64
    s_add_u32 s36, s6, 0x884000
    s_lshl_b32 s6, s11, 7
    s_add_u32 s37, s6, 0x88e000
    s_lshl_b32 s6, s10, 7
    s_add_u32 s38, s6, 0x88e800
    s_add_u32 s16, s16, 1
    s_lshl_b32 s16, s16, 4
    v_lshrrev_b32 v56, 2, v1
    v_and_b32 v56, 12, v56
    v_add_u32 v56, s16, v56
    v_and_b32 v57, 15, v1
    s_lshl_b32 s6, s11, 6
    v_add_u32 v57, s6, v57
    v_mul_u32_u24 v57, 4096, v57
    v_lshl_add_u32 v55, v56, 1, v57
    v_lshlrev_b32 v56, 2, v56
    s_sub_u32 s6, s37, 0x880000
    s_sub_u32 s7, s38, 0x880000
    v_lshl_add_u32 v57, v1, 2, s6
    v_mov_b32 v48, s7
    v_cmp_gt_u32 vcc, 8, v1
    s_nop 1
    v_cndmask_b32 v57, v48, v57, vcc
    s_mov_b32 s76, s44
    s_mov_b32 s77, s45
    s_mov_b32 s78, 0x100
    s_mov_b32 s79, 0x20000
    v_mov_b32 v21, 0
    s_waitcnt vmcnt(9)
    s_barrier
    s_add_u32 m0, s13, 73728
    s_add_u32 s14, s14, 128
    s_add_u32 s15, s15, 196608
    s_cmp_eq_u32 s14, 1280
    s_cselect_b32 s14, 0, s14
    s_cselect_b32 s15, s84, s15
    buffer_load_dwordx4 v2, s[48:51], s14 offen offset:0 lds
    buffer_load_dwordx4 v3, s[48:51], s14 offen offset:1024 lds
    buffer_load_dwordx4 v4, s[48:51], s14 offen offset:2048 lds
    buffer_load_dwordx4 v5, s[48:51], s14 offen offset:3072 lds
    s_add_u32 m0, s80, 73728
    s_nop 0
    buffer_load_dwordx4 v6, s[52:55], s15 offen offset:0 lds
    buffer_load_dwordx4 v7, s[52:55], s15 offen offset:1024 lds
    buffer_load_dwordx4 v8, s[52:55], s15 offen offset:2048 lds
    buffer_load_dwordx4 v9, s[52:55], s15 offen offset:3072 lds
    s_add_u32 m0, s80, 77824
    s_nop 0
    buffer_load_dwordx4 v10, s[52:55], s15 offen lds
    s_waitcnt vmcnt(9)
    s_barrier
    s_add_u32 m0, s13, 110592
    s_add_u32 s14, s14, 128
    s_add_u32 s15, s15, 196608
    s_cmp_eq_u32 s14, 1280
    s_cselect_b32 s14, 0, s14
    s_cselect_b32 s15, s84, s15
    buffer_load_dwordx4 v2, s[48:51], s14 offen offset:0 lds
    buffer_load_dwordx4 v3, s[48:51], s14 offen offset:1024 lds
    buffer_load_dwordx4 v4, s[48:51], s14 offen offset:2048 lds
    buffer_load_dwordx4 v5, s[48:51], s14 offen offset:3072 lds
    s_add_u32 m0, s80, 110592
    s_nop 0
    buffer_load_dwordx4 v6, s[52:55], s15 offen offset:0 lds
    buffer_load_dwordx4 v7, s[52:55], s15 offen offset:1024 lds
    buffer_load_dwordx4 v8, s[52:55], s15 offen offset:2048 lds
    buffer_load_dwordx4 v9, s[52:55], s15 offen offset:3072 lds
    s_add_u32 m0, s80, 114688
    s_nop 0
    buffer_load_dwordx4 v10, s[52:55], s15 offen lds
    s_waitcnt vmcnt(9)
    s_barrier
    s_mov_b32 m0, s13
    s_add_u32 s14, s14, 128
    s_add_u32 s15, s15, 196608
    s_cmp_eq_u32 s14, 1280
    s_cselect_b32 s14, 0, s14
    s_cselect_b32 s15, s84, s15
    buffer_load_dwordx4 v2, s[48:51], s14 offen offset:0 lds
    buffer_load_dwordx4 v3, s[48:51], s14 offen offset:1024 lds
    buffer_load_dwordx4 v4, s[48:51], s14 offen offset:2048 lds
    buffer_load_dwordx4 v5, s[48:51], s14 offen offset:3072 lds
    s_add_u32 m0, s80, 0
    s_nop 0
    buffer_load_dwordx4 v6, s[52:55], s15 offen offset:0 lds
    buffer_load_dwordx4 v7, s[52:55], s15 offen offset:1024 lds
    buffer_load_dwordx4 v8, s[52:55], s15 offen offset:2048 lds
    buffer_load_dwordx4 v9, s[52:55], s15 offen offset:3072 lds
    s_add_u32 m0, s80, 4096
    s_nop 0
    buffer_load_dwordx4 v10, s[52:55], s15 offen lds
    s_add_u32 s6, s81, 204800
    s_add_u32 m0, s83, 147456
    s_cmp_ge_u32 s6, s82
    s_cselect_b32 s7, 1966080, 0
    s_sub_u32 s6, s6, s7
    buffer_load_dwordx4 v11, s[56:59], s6 offen lds
    s_add_u32 s6, s81, 327680
    s_add_u32 m0, s83, 151552
    s_cmp_ge_u32 s6, s82
    s_cselect_b32 s7, 1966080, 0
    s_sub_u32 s6, s6, s7
    buffer_load_dwordx4 v11, s[56:59], s6 offen lds
    s_add_u32 s6, s81, 655360
    s_add_u32 m0, s83, 155648
    s_cmp_ge_u32 s6, s82
    s_cselect_b32 s7, 1966080, 0
    s_sub_u32 s6, s6, s7
    buffer_load_dwordx4 v11, s[56:59], s6 offen lds
    s_add_u32 s6, s81, 778240
    s_add_u32 m0, s83, 159744
    s_cmp_ge_u32 s6, s82
    s_cselect_b32 s7, 1966080, 0
    s_sub_u32 s6, s6, s7
    buffer_load_dwordx4 v11, s[56:59], s6 offen lds
    s_waitcnt vmcnt(13)
    s_barrier
    s_add_u32 m0, s13, 36864
    s_add_u32 s14, s14, 128
    s_add_u32 s15, s15, 196608
    s_cmp_eq_u32 s14, 1280
    s_cselect_b32 s14, 0, s14
    s_cselect_b32 s15, s84, s15
    buffer_load_dwordx4 v2, s[48:51], s14 offen offset:0 lds
    buffer_load_dwordx4 v3, s[48:51], s14 offen offset:1024 lds
    buffer_load_dwordx4 v4, s[48:51], s14 offen offset:2048 lds
    buffer_load_dwordx4 v5, s[48:51], s14 offen offset:3072 lds
    s_add_u32 m0, s80, 36864
    s_nop 0
    buffer_load_dwordx4 v6, s[52:55], s15 offen offset:0 lds
    buffer_load_dwordx4 v7, s[52:55], s15 offen offset:1024 lds
    buffer_load_dwordx4 v8, s[52:55], s15 offen offset:2048 lds
    buffer_load_dwordx4 v9, s[52:55], s15 offen offset:3072 lds
    s_add_u32 m0, s80, 40960
    s_nop 0
    buffer_load_dwordx4 v10, s[52:55], s15 offen lds
    s_waitcnt vmcnt(13)
    s_waitcnt vmcnt(9)
    s_barrier
    s_add_u32 m0, s13, 73728
    s_add_u32 s14, s14, 128
    s_add_u32 s15, s15, 196608
    s_cmp_eq_u32 s14, 1280
    s_cselect_b32 s14, 0, s14
    s_cselect_b32 s15, s84, s15
    buffer_load_dwordx4 v2, s[48:51], s14 offen offset:0 lds
    buffer_load_dwordx4 v3, s[48:51], s14 offen offset:1024 lds
    buffer_load_dwordx4 v4, s[48:51], s14 offen offset:2048 lds
    buffer_load_dwordx4 v5, s[48:51], s14 offen offset:3072 lds
    s_add_u32 m0, s80, 73728
    s_nop 0
    buffer_load_dwordx4 v6, s[52:55], s15 offen offset:0 lds
    buffer_load_dwordx4 v7, s[52:55], s15 offen offset:1024 lds
    buffer_load_dwordx4 v8, s[52:55], s15 offen offset:2048 lds
    buffer_load_dwordx4 v9, s[52:55], s15 offen offset:3072 lds
    s_add_u32 m0, s80, 77824
    s_nop 0
    buffer_load_dwordx4 v10, s[52:55], s15 offen lds
    ds_read_b64_tr_b16 v[64:65], v12 offset:0
    ds_read_b64_tr_b16 v[66:67], v12 offset:2048
    ds_read_b64_tr_b16 v[68:69], v13 offset:0
    ds_read_b64_tr_b16 v[70:71], v13 offset:2048
    ds_read_b64_tr_b16 v[72:73], v14 offset:0
    ds_read_b64_tr_b16 v[74:75], v14 offset:2048
    ds_read_b64_tr_b16 v[76:77], v15 offset:0
    ds_read_b64_tr_b16 v[78:79], v15 offset:2048
    s_waitcnt vmcnt(9)
    s_barrier
    s_add_u32 m0, s13, 110592
    s_add_u32 s14, s14, 128
    s_add_u32 s15, s15, 196608
    s_cmp_eq_u32 s14, 1280
    s_cselect_b32 s14, 0, s14
    s_cselect_b32 s15, s84, s15
    buffer_load_dwordx4 v2, s[48:51], s14 offen offset:0 lds
    buffer_load_dwordx4 v3, s[48:51], s14 offen offset:1024 lds
    buffer_load_dwordx4 v4, s[48:51], s14 offen offset:2048 lds
    buffer_load_dwordx4 v5, s[48:51], s14 offen offset:3072 lds
    s_add_u32 m0, s80, 110592
    s_nop 0
    buffer_load_dwordx4 v6, s[52:55], s15 offen offset:0 lds
    buffer_load_dwordx4 v7, s[52:55], s15 offen offset:1024 lds
    buffer_load_dwordx4 v8, s[52:55], s15 offen offset:2048 lds
    buffer_load_dwordx4 v9, s[52:55], s15 offen offset:3072 lds
    s_add_u32 m0, s80, 114688
    s_nop 0
    buffer_load_dwordx4 v10, s[52:55], s15 offen lds
    ds_read_b64_tr_b16 v[80:81], v12 offset:4096
    ds_read_b64_tr_b16 v[82:83], v12 offset:6144
    ds_read_b64_tr_b16 v[84:85], v13 offset:4096
    ds_read_b64_tr_b16 v[86:87], v13 offset:6144
    ds_read_b64_tr_b16 v[88:89], v14 offset:4096
    ds_read_b64_tr_b16 v[90:91], v14 offset:6144
    ds_read_b64_tr_b16 v[92:93], v15 offset:4096
    ds_read_b64_tr_b16 v[94:95], v15 offset:6144
    s_waitcnt vmcnt(9)
    s_barrier
    s_mov_b32 m0, s13
    s_add_u32 s14, s14, 128
    s_add_u32 s15, s15, 196608
    s_cmp_eq_u32 s14, 1280
    s_cselect_b32 s14, 0, s14
    s_cselect_b32 s15, s84, s15
    buffer_load_dwordx4 v2, s[48:51], s14 offen offset:0 lds
    buffer_load_dwordx4 v3, s[48:51], s14 offen offset:1024 lds
    buffer_load_dwordx4 v4, s[48:51], s14 offen offset:2048 lds
    buffer_load_dwordx4 v5, s[48:51], s14 offen offset:3072 lds
    s_add_u32 m0, s80, 0
    s_nop 0
    buffer_load_dwordx4 v6, s[52:55], s15 offen offset:0 lds
    buffer_load_dwordx4 v7, s[52:55], s15 offen offset:1024 lds
    buffer_load_dwordx4 v8, s[52:55], s15 offen offset:2048 lds
    buffer_load_dwordx4 v9, s[52:55], s15 offen offset:3072 lds
    s_add_u32 m0, s80, 4096
    s_nop 0
    buffer_load_dwordx4 v10, s[52:55], s15 offen lds
    ds_read_b64_tr_b16 v[96:97], v12 offset:8192
    ds_read_b64_tr_b16 v[98:99], v12 offset:10240
    ds_read_b64_tr_b16 v[100:101], v13 offset:8192
    ds_read_b64_tr_b16 v[102:103], v13 offset:10240
    ds_read_b64_tr_b16 v[104:105], v14 offset:8192
    ds_read_b64_tr_b16 v[106:107], v14 offset:10240
    ds_read_b64_tr_b16 v[108:109], v15 offset:8192
    ds_read_b64_tr_b16 v[110:111], v15 offset:10240
    ds_read_b64_tr_b16 v[112:113], v12 offset:12288
    ds_read_b64_tr_b16 v[114:115], v12 offset:14336
    ds_read_b64_tr_b16 v[116:117], v13 offset:12288
    ds_read_b64_tr_b16 v[118:119], v13 offset:14336
    ds_read_b64_tr_b16 v[120:121], v14 offset:12288
    ds_read_b64_tr_b16 v[122:123], v14 offset:14336
    ds_read_b64_tr_b16 v[124:125], v15 offset:12288
    ds_read_b64_tr_b16 v[126:127], v15 offset:14336
    s_waitcnt vmcnt(9) lgkmcnt(0)
    s_barrier
    s_add_u32 m0, s13, 36864
    s_add_u32 s14, s14, 128
    s_add_u32 s15, s15, 196608
    s_cmp_eq_u32 s14, 1280
    s_cselect_b32 s14, 0, s14
    s_cselect_b32 s15, s84, s15
    buffer_load_dwordx4 v2, s[48:51], s14 offen offset:0 lds
    buffer_load_dwordx4 v3, s[48:51], s14 offen offset:1024 lds
    buffer_load_dwordx4 v4, s[48:51], s14 offen offset:2048 lds
    buffer_load_dwordx4 v5, s[48:51], s14 offen offset:3072 lds
    s_add_u32 m0, s80, 36864
    s_nop 0
    buffer_load_dwordx4 v6, s[52:55], s15 offen offset:0 lds
    buffer_load_dwordx4 v7, s[52:55], s15 offen offset:1024 lds
    buffer_load_dwordx4 v8, s[52:55], s15 offen offset:2048 lds
    buffer_load_dwordx4 v9, s[52:55], s15 offen offset:3072 lds
    s_add_u32 m0, s80, 40960
    s_nop 0
    buffer_load_dwordx4 v10, s[52:55], s15 offen lds
    s_add_u32 s6, s81, 1105920
    s_add_u32 m0, s83, 147456
    s_cmp_ge_u32 s6, s82
    s_cselect_b32 s7, 1966080, 0
    s_sub_u32 s6, s6, s7
    buffer_load_dwordx4 v11, s[56:59], s6 offen lds
    s_add_u32 s6, s81, 1433600
    s_add_u32 m0, s83, 151552
    s_cmp_ge_u32 s6, s82
    s_cselect_b32 s7, 1966080, 0
    s_sub_u32 s6, s6, s7
    buffer_load_dwordx4 v11, s[56:59], s6 offen lds
    s_add_u32 s6, s81, 1556480
    s_add_u32 m0, s83, 155648
    s_cmp_ge_u32 s6, s82
    s_cselect_b32 s7, 1966080, 0
    s_sub_u32 s6, s6, s7
    buffer_load_dwordx4 v11, s[56:59], s6 offen lds
    s_add_u32 s6, s81, 1884160
    s_add_u32 m0, s83, 159744
    s_cmp_ge_u32 s6, s82
    s_cselect_b32 s7, 1966080, 0
    s_sub_u32 s6, s6, s7
    buffer_load_dwordx4 v11, s[56:59], s6 offen lds
    s_waitcnt vmcnt(13)
    s_barrier
    s_add_u32 s6, s81, 0
    s_add_u32 m0, s83, 73728
    s_cmp_ge_u32 s6, s82
    s_cselect_b32 s7, 1966080, 0
    s_sub_u32 s6, s6, s7
    buffer_load_dwordx4 v11, s[56:59], s6 offen lds
    s_add_u32 s6, s81, 40960
    s_add_u32 m0, s83, 77824
    s_cmp_ge_u32 s6, s82
    s_cselect_b32 s7, 1966080, 0
    s_sub_u32 s6, s6, s7
    buffer_load_dwordx4 v11, s[56:59], s6 offen lds
    s_add_u32 s6, s81, 81920
    s_add_u32 m0, s83, 81920
    s_cmp_ge_u32 s6, s82
    s_cselect_b32 s7, 1966080, 0
    s_sub_u32 s6, s6, s7
    buffer_load_dwordx4 v11, s[56:59], s6 offen lds
    s_add_u32 s6, s81, 122880
    s_add_u32 m0, s83, 86016
    s_cmp_ge_u32 s6, s82
    s_cselect_b32 s7, 1966080, 0
    s_sub_u32 s6, s6, s7
    buffer_load_dwordx4 v11, s[56:59], s6 offen lds
    s_add_u32 s6, s81, 163840
    s_add_u32 m0, s83, 90112
    s_cmp_ge_u32 s6, s82
    s_cselect_b32 s7, 1966080, 0
    s_sub_u32 s6, s6, s7
    buffer_load_dwordx4 v11, s[56:59], s6 offen lds
    s_add_u32 s6, s81, 450560
    s_add_u32 m0, s83, 94208
    s_cmp_ge_u32 s6, s82
    s_cselect_b32 s7, 1966080, 0
    s_sub_u32 s6, s6, s7
    buffer_load_dwordx4 v11, s[56:59], s6 offen lds
    s_add_u32 s6, s81, 532480
    s_add_u32 m0, s83, 98304
    s_cmp_ge_u32 s6, s82
    s_cselect_b32 s7, 1966080, 0
    s_sub_u32 s6, s6, s7
    buffer_load_dwordx4 v11, s[56:59], s6 offen lds
    s_add_u32 s6, s81, 819200
    s_add_u32 m0, s83, 102400
    s_cmp_ge_u32 s6, s82
    s_cselect_b32 s7, 1966080, 0
    s_sub_u32 s6, s6, s7
    buffer_load_dwordx4 v11, s[56:59], s6 offen lds
    s_add_u32 s6, s81, 901120
    s_add_u32 m0, s83, 106496
    s_cmp_ge_u32 s6, s82
    s_cselect_b32 s7, 1966080, 0
    s_sub_u32 s6, s6, s7
    buffer_load_dwordx4 v11, s[56:59], s6 offen lds
    s_load_dword s20, s[44:45], 0
    s_waitcnt vmcnt(13)
    s_barrier
    s_add_u32 s6, s81, 983040
    s_add_u32 m0, s83, 110592
    s_cmp_ge_u32 s6, s82
    s_cselect_b32 s7, 1966080, 0
    s_sub_u32 s6, s6, s7
    buffer_load_dwordx4 v11, s[56:59], s6 offen lds
    s_add_u32 s6, s81, 1269760
    s_add_u32 m0, s83, 114688
    s_cmp_ge_u32 s6, s82
    s_cselect_b32 s7, 1966080, 0
    s_sub_u32 s6, s6, s7
    buffer_load_dwordx4 v11, s[56:59], s6 offen lds
    s_add_u32 s6, s81, 1351680
    s_add_u32 m0, s83, 118784
    s_cmp_ge_u32 s6, s82
    s_cselect_b32 s7, 1966080, 0
    s_sub_u32 s6, s6, s7
    buffer_load_dwordx4 v11, s[56:59], s6 offen lds
    s_add_u32 s6, s81, 1638400
    s_add_u32 m0, s83, 122880
    s_cmp_ge_u32 s6, s82
    s_cselect_b32 s7, 1966080, 0
    s_sub_u32 s6, s6, s7
    buffer_load_dwordx4 v11, s[56:59], s6 offen lds
    s_add_u32 s6, s81, 409600
    s_add_u32 m0, s83, 126976
    s_cmp_ge_u32 s6, s82
    s_cselect_b32 s7, 1966080, 0
    s_sub_u32 s6, s6, s7
    buffer_load_dwordx4 v11, s[56:59], s6 offen lds
    s_add_u32 s6, s81, 491520
    s_add_u32 m0, s83, 131072
    s_cmp_ge_u32 s6, s82
    s_cselect_b32 s7, 1966080, 0
    s_sub_u32 s6, s6, s7
    buffer_load_dwordx4 v11, s[56:59], s6 offen lds
    s_add_u32 s6, s81, 573440
    s_add_u32 m0, s83, 135168
    s_cmp_ge_u32 s6, s82
    s_cselect_b32 s7, 1966080, 0
    s_sub_u32 s6, s6, s7
    buffer_load_dwordx4 v11, s[56:59], s6 offen lds
    s_add_u32 s6, s81, 860160
    s_add_u32 m0, s83, 139264
    s_cmp_ge_u32 s6, s82
    s_cselect_b32 s7, 1966080, 0
    s_sub_u32 s6, s6, s7
    buffer_load_dwordx4 v11, s[56:59], s6 offen lds
    s_waitcnt vmcnt(17)
    s_waitcnt vmcnt(11) lgkmcnt(0)
    s_cmp_lg_u32 s20, 1
    s_cbranch_scc1 LNR_1
LRD_2:
    s_barrier
    ds_read_b64_tr_b16 v[128:129], v12 offset:0
    ds_read_b64_tr_b16 v[130:131], v12 offset:2048
    ds_read_b64_tr_b16 v[132:133], v13 offset:0
    ds_read_b64_tr_b16 v[134:135], v13 offset:2048
    ds_read_b64_tr_b16 v[136:137], v14 offset:0
    ds_read_b64_tr_b16 v[138:139], v14 offset:2048
    ds_read_b64_tr_b16 v[140:141], v15 offset:0
    ds_read_b64_tr_b16 v[142:143], v15 offset:2048
    ds_read_b64_tr_b16 v[144:145], v12 offset:4096
    ds_read_b64_tr_b16 v[146:147], v12 offset:6144
    ds_read_b64_tr_b16 v[148:149], v13 offset:4096
    ds_read_b64_tr_b16 v[150:151], v13 offset:6144
    ds_read_b64_tr_b16 v[152:153], v14 offset:4096
    ds_read_b64_tr_b16 v[154:155], v14 offset:6144
    ds_read_b64_tr_b16 v[156:157], v15 offset:4096
    ds_read_b64_tr_b16 v[158:159], v15 offset:6144
    ds_read_b64_tr_b16 v[160:161], v12 offset:8192
    ds_read_b64_tr_b16 v[162:163], v12 offset:10240
    ds_read_b64_tr_b16 v[164:165], v13 offset:8192
    ds_read_b64_tr_b16 v[166:167], v13 offset:10240
    ds_read_b64_tr_b16 v[168:169], v14 offset:8192
    ds_read_b64_tr_b16 v[170:171], v14 offset:10240
    ds_read_b64_tr_b16 v[172:173], v15 offset:8192
    ds_read_b64_tr_b16 v[174:175], v15 offset:10240
    ds_read_b64_tr_b16 v[176:177], v12 offset:12288
    ds_read_b64_tr_b16 v[178:179], v12 offset:14336
    ds_read_b64_tr_b16 v[180:181], v13 offset:12288
    ds_read_b64_tr_b16 v[182:183], v13 offset:14336
    ds_read_b64_tr_b16 v[184:185], v14 offset:12288
    ds_read_b64_tr_b16 v[186:187], v14 offset:14336
    ds_read_b64_tr_b16 v[188:189], v15 offset:12288
    ds_read_b64_tr_b16 v[190:191], v15 offset:14336
    s_add_u32 s6, s81, 942080
    s_add_u32 m0, s83, 143360
    s_cmp_ge_u32 s6, s82
    s_cselect_b32 s7, 1966080, 0
    s_sub_u32 s6, s6, s7
    buffer_load_dwordx4 v11, s[56:59], s6 offen lds
    s_add_u32 s6, s81, 1228800
    s_add_u32 m0, s83, 0
    s_cmp_ge_u32 s6, s82
    s_cselect_b32 s7, 1966080, 0
    s_sub_u32 s6, s6, s7
    buffer_load_dwordx4 v11, s[56:59], s6 offen lds
    s_add_u32 s6, s81, 1310720
    s_add_u32 m0, s83, 4096
    s_cmp_ge_u32 s6, s82
    s_cselect_b32 s7, 1966080, 0
    s_sub_u32 s6, s6, s7
    buffer_load_dwordx4 v11, s[56:59], s6 offen lds
    s_add_u32 s6, s81, 1392640
    s_add_u32 m0, s83, 8192
    s_cmp_ge_u32 s6, s82
    s_cselect_b32 s7, 1966080, 0
    s_sub_u32 s6, s6, s7
    buffer_load_dwordx4 v11, s[56:59], s6 offen lds
    s_add_u32 s6, s81, 1679360
    s_add_u32 m0, s83, 12288
    s_cmp_ge_u32 s6, s82
    s_cselect_b32 s7, 1966080, 0
    s_sub_u32 s6, s6, s7
    buffer_load_dwordx4 v11, s[56:59], s6 offen lds
    s_add_u32 s6, s81, 1720320
    s_add_u32 m0, s83, 16384
    s_cmp_ge_u32 s6, s82
    s_cselect_b32 s7, 1966080, 0
    s_sub_u32 s6, s6, s7
    buffer_load_dwordx4 v11, s[56:59], s6 offen lds
    s_add_u32 s6, s81, 1761280
    s_add_u32 m0, s83, 20480
    s_cmp_ge_u32 s6, s82
    s_cselect_b32 s7, 1966080, 0
    s_sub_u32 s6, s6, s7
    buffer_load_dwordx4 v11, s[56:59], s6 offen lds
    s_add_u32 s6, s81, 1802240
    s_add_u32 m0, s83, 24576
    s_cmp_ge_u32 s6, s82
    s_cselect_b32 s7, 1966080, 0
    s_sub_u32 s6, s6, s7
    buffer_load_dwordx4 v11, s[56:59], s6 offen lds
    s_add_u32 s6, s81, 245760
    s_add_u32 m0, s83, 28672
    s_cmp_ge_u32 s6, s82
    s_cselect_b32 s7, 1966080, 0
    s_sub_u32 s6, s6, s7
    buffer_load_dwordx4 v11, s[56:59], s6 offen lds
    s_add_u32 s6, s81, 286720
    s_add_u32 m0, s83, 32768
    s_cmp_ge_u32 s6, s82
    s_cselect_b32 s7, 1966080, 0
    s_sub_u32 s6, s6, s7
    buffer_load_dwordx4 v11, s[56:59], s6 offen lds
    s_add_u32 s6, s81, 368640
    s_add_u32 m0, s83, 36864
    s_cmp_ge_u32 s6, s82
    s_cselect_b32 s7, 1966080, 0
    s_sub_u32 s6, s6, s7
    buffer_load_dwordx4 v11, s[56:59], s6 offen lds
    s_add_u32 s6, s81, 614400
    s_add_u32 m0, s83, 40960
    s_cmp_ge_u32 s6, s82
    s_cselect_b32 s7, 1966080, 0
    s_sub_u32 s6, s6, s7
    buffer_load_dwordx4 v11, s[56:59], s6 offen lds
    s_add_u32 s6, s81, 696320
    s_add_u32 m0, s83, 45056
    s_cmp_ge_u32 s6, s82
    s_cselect_b32 s7, 1966080, 0
    s_sub_u32 s6, s6, s7
    buffer_load_dwordx4 v11, s[56:59], s6 offen lds
    s_add_u32 s6, s81, 737280
    s_add_u32 m0, s83, 49152
    s_cmp_ge_u32 s6, s82
    s_cselect_b32 s7, 1966080, 0
    s_sub_u32 s6, s6, s7
    buffer_load_dwordx4 v11, s[56:59], s6 offen lds
    s_add_u32 s6, s81, 1024000
    s_add_u32 m0, s83, 53248
    s_cmp_ge_u32 s6, s82
    s_cselect_b32 s7, 1966080, 0
    s_sub_u32 s6, s6, s7
    buffer_load_dwordx4 v11, s[56:59], s6 offen lds
    s_add_u32 s6, s81, 1064960
    s_add_u32 m0, s83, 57344
    s_cmp_ge_u32 s6, s82
    s_cselect_b32 s7, 1966080, 0
    s_sub_u32 s6, s6, s7
    buffer_load_dwordx4 v11, s[56:59], s6 offen lds
    s_add_u32 s6, s81, 1146880
    s_add_u32 m0, s83, 61440
    s_cmp_ge_u32 s6, s82
    s_cselect_b32 s7, 1966080, 0
    s_sub_u32 s6, s6, s7
    buffer_load_dwordx4 v11, s[56:59], s6 offen lds
    s_add_u32 s6, s81, 1187840
    s_add_u32 m0, s83, 65536
    s_cmp_ge_u32 s6, s82
    s_cselect_b32 s7, 1966080, 0
    s_sub_u32 s6, s6, s7
    buffer_load_dwordx4 v11, s[56:59], s6 offen lds
    s_add_u32 s6, s81, 1474560
    s_add_u32 m0, s83, 69632
    s_cmp_ge_u32 s6, s82
    s_cselect_b32 s7, 1966080, 0
    s_sub_u32 s6, s6, s7
    buffer_load_dwordx4 v11, s[56:59], s6 offen lds
    s_waitcnt lgkmcnt(0)
    s_barrier
    s_add_u32 s6, s81, 1515520
    s_add_u32 m0, s83, 147456
    s_cmp_ge_u32 s6, s82
    s_cselect_b32 s7, 1966080, 0
    s_sub_u32 s6, s6, s7
    buffer_load_dwordx4 v11, s[56:59], s6 offen lds
    s_add_u32 s6, s81, 1597440
    s_add_u32 m0, s83, 151552
    s_cmp_ge_u32 s6, s82
    s_cselect_b32 s7, 1966080, 0
    s_sub_u32 s6, s6, s7
    buffer_load_dwordx4 v11, s[56:59], s6 offen lds
    s_add_u32 s6, s81, 1843200
    s_add_u32 m0, s83, 155648
    s_cmp_ge_u32 s6, s82
    s_cselect_b32 s7, 1966080, 0
    s_sub_u32 s6, s6, s7
    buffer_load_dwordx4 v11, s[56:59], s6 offen lds
    s_add_u32 s6, s81, 1925120
    s_add_u32 m0, s83, 159744
    s_cmp_ge_u32 s6, s82
    s_cselect_b32 s7, 1966080, 0
    s_sub_u32 s6, s6, s7
    buffer_load_dwordx4 v11, s[56:59], s6 offen lds
    s_waitcnt vmcnt(0)
    s_barrier
    buffer_load_dwordx4 v[192:195], v60, s[60:63], s17 offen sc1
    buffer_load_dwordx4 v[196:199], v61, s[60:63], s17 offen sc1
    s_add_u32 s17, s17, 2048
    s_cmp_ge_u32 s17, 49152
    s_cselect_b32 s6, 49152, 0
    s_sub_u32 s17, s17, s6
    buffer_load_dwordx4 v[200:203], v60, s[60:63], s17 offen sc1
    buffer_load_dwordx4 v[204:207], v61, s[60:63], s17 offen sc1
    s_add_u32 s17, s17, 2048
    s_cmp_ge_u32 s17, 49152
    s_cselect_b32 s6, 49152, 0
    s_sub_u32 s17, s17, s6
    buffer_load_dwordx4 v[208:211], v60, s[60:63], s17 offen sc1
    buffer_load_dwordx4 v[212:215], v61, s[60:63], s17 offen sc1
    s_add_u32 s17, s17, 7168
    s_cmp_ge_u32 s17, 49152
    s_cselect_b32 s6, 49152, 0
    s_sub_u32 s17, s17, s6
    buffer_load_dwordx4 v[216:219], v60, s[60:63], s17 offen sc1
    buffer_load_dwordx4 v[220:223], v61, s[60:63], s17 offen sc1
    s_add_u32 s17, s17, 2048
    s_cmp_ge_u32 s17, 49152
    s_cselect_b32 s6, 49152, 0
    s_sub_u32 s17, s17, s6
    buffer_load_dwordx4 v[4:7], v60, s[60:63], s17 offen sc1
    buffer_load_dwordx4 v[8:11], v61, s[60:63], s17 offen sc1
    s_add_u32 s17, s17, 7168
    s_cmp_ge_u32 s17, 49152
    s_cselect_b32 s6, 49152, 0
    s_sub_u32 s17, s17, s6
    s_waitcnt vmcnt(10)
    v_add_u32 v12, 0xffffb000, v12
    v_add_u32 v13, 0xffffb000, v13
    v_add_u32 v14, 0xffffb000, v14
    v_add_u32 v15, 0xffffb000, v15
    ds_read_b64_tr_b16 v[16:17], v12 offset:0
    ds_read_b64_tr_b16 v[18:19], v12 offset:2048
    ds_read_b64_tr_b16 v[20:21], v13 offset:0
    ds_read_b64_tr_b16 v[22:23], v13 offset:2048
    ds_read_b64_tr_b16 v[24:25], v14 offset:0
    ds_read_b64_tr_b16 v[26:27], v14 offset:2048
    ds_read_b64_tr_b16 v[28:29], v15 offset:0
    ds_read_b64_tr_b16 v[30:31], v15 offset:2048
    s_waitcnt vmcnt(8) lgkmcnt(0)
    v_mfma_f32_16x16x32_bf16 v[224:227], v[192:195], v[16:19], 0
    ds_read_b64_tr_b16 v[32:33], v12 offset:4096
    ds_read_b64_tr_b16 v[34:35], v12 offset:6144
    ds_read_b64_tr_b16 v[36:37], v13 offset:4096
    v_mfma_f32_16x16x32_bf16 v[228:231], v[192:195], v[20:23], 0
    ds_read_b64_tr_b16 v[38:39], v13 offset:6144
    ds_read_b64_tr_b16 v[40:41], v14 offset:4096
    ds_read_b64_tr_b16 v[42:43], v14 offset:6144
    v_mfma_f32_16x16x32_bf16 v[232:235], v[192:195], v[24:27], 0
    ds_read_b64_tr_b16 v[44:45], v15 offset:4096
    ds_read_b64_tr_b16 v[46:47], v15 offset:6144
    v_mfma_f32_16x16x32_bf16 v[236:239], v[192:195], v[28:31], 0
    v_mfma_f32_16x16x32_bf16 v[240:243], v[196:199], v[16:19], 0
    v_mfma_f32_16x16x32_bf16 v[244:247], v[196:199], v[20:23], 0
    v_mfma_f32_16x16x32_bf16 v[248:251], v[196:199], v[24:27], 0
    v_mfma_f32_16x16x32_bf16 v[252:255], v[196:199], v[28:31], 0
    s_waitcnt vmcnt(6) lgkmcnt(0)
    v_mfma_f32_16x16x32_bf16 v[224:227], v[200:203], v[32:35], v[224:227]
    ds_read_b64_tr_b16 v[16:17], v12 offset:8192
    ds_read_b64_tr_b16 v[18:19], v12 offset:10240
    ds_read_b64_tr_b16 v[20:21], v13 offset:8192
    v_mfma_f32_16x16x32_bf16 v[228:231], v[200:203], v[36:39], v[228:231]
    ds_read_b64_tr_b16 v[22:23], v13 offset:10240
    ds_read_b64_tr_b16 v[24:25], v14 offset:8192
    ds_read_b64_tr_b16 v[26:27], v14 offset:10240
    v_mfma_f32_16x16x32_bf16 v[232:235], v[200:203], v[40:43], v[232:235]
    ds_read_b64_tr_b16 v[28:29], v15 offset:8192
    ds_read_b64_tr_b16 v[30:31], v15 offset:10240
    v_mfma_f32_16x16x32_bf16 v[236:239], v[200:203], v[44:47], v[236:239]
    buffer_load_dwordx4 v[192:195], v60, s[60:63], s17 offen sc1
    buffer_load_dwordx4 v[196:199], v61, s[60:63], s17 offen sc1
    s_add_u32 s17, s17, 2048
    s_cmp_ge_u32 s17, 49152
    s_cselect_b32 s6, 49152, 0
    s_sub_u32 s17, s17, s6
    v_mfma_f32_16x16x32_bf16 v[240:243], v[204:207], v[32:35], v[240:243]
    v_mfma_f32_16x16x32_bf16 v[244:247], v[204:207], v[36:39], v[244:247]
    v_mfma_f32_16x16x32_bf16 v[248:251], v[204:207], v[40:43], v[248:251]
    v_mfma_f32_16x16x32_bf16 v[252:255], v[204:207], v[44:47], v[252:255]
    s_waitcnt vmcnt(6) lgkmcnt(0)
    v_mfma_f32_16x16x32_bf16 v[224:227], v[208:211], v[16:19], v[224:227]
    ds_read_b64_tr_b16 v[32:33], v12 offset:12288
    ds_read_b64_tr_b16 v[34:35], v12 offset:14336
    ds_read_b64_tr_b16 v[36:37], v13 offset:12288
    v_mfma_f32_16x16x32_bf16 v[228:231], v[208:211], v[20:23], v[228:231]
    ds_read_b64_tr_b16 v[38:39], v13 offset:14336
    ds_read_b64_tr_b16 v[40:41], v14 offset:12288
    ds_read_b64_tr_b16 v[42:43], v14 offset:14336
    v_mfma_f32_16x16x32_bf16 v[232:235], v[208:211], v[24:27], v[232:235]
    ds_read_b64_tr_b16 v[44:45], v15 offset:12288
    ds_read_b64_tr_b16 v[46:47], v15 offset:14336
    v_mfma_f32_16x16x32_bf16 v[236:239], v[208:211], v[28:31], v[236:239]
    buffer_load_dwordx4 v[200:203], v60, s[60:63], s17 offen sc1
    buffer_load_dwordx4 v[204:207], v61, s[60:63], s17 offen sc1
    s_add_u32 s17, s17, 2048
    s_cmp_ge_u32 s17, 49152
    s_cselect_b32 s6, 49152, 0
    s_sub_u32 s17, s17, s6
    v_mfma_f32_16x16x32_bf16 v[240:243], v[212:215], v[16:19], v[240:243]
    v_mfma_f32_16x16x32_bf16 v[244:247], v[212:215], v[20:23], v[244:247]
    v_mfma_f32_16x16x32_bf16 v[248:251], v[212:215], v[24:27], v[248:251]
    v_mfma_f32_16x16x32_bf16 v[252:255], v[212:215], v[28:31], v[252:255]
    s_waitcnt vmcnt(6) lgkmcnt(0)
    v_mfma_f32_16x16x32_bf16 v[224:227], v[216:219], v[32:35], v[224:227]
    ds_read_b64_tr_b16 v[16:17], v12 offset:16384
    ds_read_b64_tr_b16 v[18:19], v12 offset:18432
    ds_read_b64_tr_b16 v[20:21], v13 offset:16384
    v_mfma_f32_16x16x32_bf16 v[228:231], v[216:219], v[36:39], v[228:231]
    ds_read_b64_tr_b16 v[22:23], v13 offset:18432
    ds_read_b64_tr_b16 v[24:25], v14 offset:16384
    ds_read_b64_tr_b16 v[26:27], v14 offset:18432
    v_mfma_f32_16x16x32_bf16 v[232:235], v[216:219], v[40:43], v[232:235]
    ds_read_b64_tr_b16 v[28:29], v15 offset:16384
    ds_read_b64_tr_b16 v[30:31], v15 offset:18432
    v_mfma_f32_16x16x32_bf16 v[236:239], v[216:219], v[44:47], v[236:239]
    buffer_load_dwordx4 v[208:211], v60, s[60:63], s17 offen sc1
    buffer_load_dwordx4 v[212:215], v61, s[60:63], s17 offen sc1
    s_add_u32 s17, s17, 8192
    s_cmp_ge_u32 s17, 49152
    s_cselect_b32 s6, 49152, 0
    s_sub_u32 s17, s17, s6
    v_mfma_f32_16x16x32_bf16 v[240:243], v[220:223], v[32:35], v[240:243]
    v_mfma_f32_16x16x32_bf16 v[244:247], v[220:223], v[36:39], v[244:247]
    v_mfma_f32_16x16x32_bf16 v[248:251], v[220:223], v[40:43], v[248:251]
    v_mfma_f32_16x16x32_bf16 v[252:255], v[220:223], v[44:47], v[252:255]
    s_waitcnt vmcnt(6) lgkmcnt(0)
    v_mfma_f32_16x16x32_bf16 v[224:227], v[4:7], v[16:19], v[224:227]
    v_add_u32 v12, 0xfffe1000, v12
    v_add_u32 v13, 0xfffe1000, v13
    v_add_u32 v14, 0xfffe1000, v14
    v_mfma_f32_16x16x32_bf16 v[228:231], v[4:7], v[20:23], v[228:231]
    v_add_u32 v15, 0xfffe1000, v15
    ds_read_b64_tr_b16 v[32:33], v12 offset:0
    ds_read_b64_tr_b16 v[34:35], v12 offset:2048
    v_mfma_f32_16x16x32_bf16 v[232:235], v[4:7], v[24:27], v[232:235]
    ds_read_b64_tr_b16 v[36:37], v13 offset:0
    ds_read_b64_tr_b16 v[38:39], v13 offset:2048
    ds_read_b64_tr_b16 v[40:41], v14 offset:0
    v_mfma_f32_16x16x32_bf16 v[236:239], v[4:7], v[28:31], v[236:239]
    buffer_load_dwordx4 v[216:219], v60, s[60:63], s17 offen sc1
    buffer_load_dwordx4 v[220:223], v61, s[60:63], s17 offen sc1
    s_add_u32 s17, s17, 11264
    s_cmp_ge_u32 s17, 49152
    s_cselect_b32 s6, 49152, 0
    s_sub_u32 s17, s17, s6
    ds_read_b64_tr_b16 v[42:43], v14 offset:2048
    ds_read_b64_tr_b16 v[44:45], v15 offset:0
    ds_read_b64_tr_b16 v[46:47], v15 offset:2048
    v_mfma_f32_16x16x32_bf16 v[240:243], v[8:11], v[16:19], v[240:243]
    v_mfma_f32_16x16x32_bf16 v[244:247], v[8:11], v[20:23], v[244:247]
    v_mfma_f32_16x16x32_bf16 v[248:251], v[8:11], v[24:27], v[248:251]
    v_mfma_f32_16x16x32_bf16 v[252:255], v[8:11], v[28:31], v[252:255]
    s_waitcnt vmcnt(6) lgkmcnt(0)
    v_mfma_f32_16x16x32_bf16 v[224:227], v[192:195], v[32:35], v[224:227]
    ds_read_b64_tr_b16 v[16:17], v12 offset:4096
    ds_read_b64_tr_b16 v[18:19], v12 offset:6144
    ds_read_b64_tr_b16 v[20:21], v13 offset:4096
    v_mfma_f32_16x16x32_bf16 v[228:231], v[192:195], v[36:39], v[228:231]
    ds_read_b64_tr_b16 v[22:23], v13 offset:6144
    ds_read_b64_tr_b16 v[24:25], v14 offset:4096
    ds_read_b64_tr_b16 v[26:27], v14 offset:6144
    v_mfma_f32_16x16x32_bf16 v[232:235], v[192:195], v[40:43], v[232:235]
    ds_read_b64_tr_b16 v[28:29], v15 offset:4096
    ds_read_b64_tr_b16 v[30:31], v15 offset:6144
    v_mfma_f32_16x16x32_bf16 v[236:239], v[192:195], v[44:47], v[236:239]
    buffer_load_dwordx4 v[4:7], v60, s[60:63], s17 offen sc1
    buffer_load_dwordx4 v[8:11], v61, s[60:63], s17 offen sc1
    s_add_u32 s17, s17, 3072
    s_cmp_ge_u32 s17, 49152
    s_cselect_b32 s6, 49152, 0
    s_sub_u32 s17, s17, s6
    v_mfma_f32_16x16x32_bf16 v[240:243], v[196:199], v[32:35], v[240:243]
    v_mfma_f32_16x16x32_bf16 v[244:247], v[196:199], v[36:39], v[244:247]
    v_mfma_f32_16x16x32_bf16 v[248:251], v[196:199], v[40:43], v[248:251]
    v_mfma_f32_16x16x32_bf16 v[252:255], v[196:199], v[44:47], v[252:255]
    s_waitcnt vmcnt(6) lgkmcnt(0)
    v_mfma_f32_16x16x32_bf16 v[224:227], v[200:203], v[16:19], v[224:227]
    ds_read_b64_tr_b16 v[32:33], v12 offset:8192
    ds_read_b64_tr_b16 v[34:35], v12 offset:10240
    ds_read_b64_tr_b16 v[36:37], v13 offset:8192
    v_mfma_f32_16x16x32_bf16 v[228:231], v[200:203], v[20:23], v[228:231]
    ds_read_b64_tr_b16 v[38:39], v13 offset:10240
    ds_read_b64_tr_b16 v[40:41], v14 offset:8192
    ds_read_b64_tr_b16 v[42:43], v14 offset:10240
    v_mfma_f32_16x16x32_bf16 v[232:235], v[200:203], v[24:27], v[232:235]
    ds_read_b64_tr_b16 v[44:45], v15 offset:8192
    ds_read_b64_tr_b16 v[46:47], v15 offset:10240
    v_mfma_f32_16x16x32_bf16 v[236:239], v[200:203], v[28:31], v[236:239]
    buffer_load_dwordx4 v[192:195], v60, s[60:63], s17 offen sc1
    buffer_load_dwordx4 v[196:199], v61, s[60:63], s17 offen sc1
    s_add_u32 s17, s17, 8192
    s_cmp_ge_u32 s17, 49152
    s_cselect_b32 s6, 49152, 0
    s_sub_u32 s17, s17, s6
    v_mfma_f32_16x16x32_bf16 v[240:243], v[204:207], v[16:19], v[240:243]
    v_mfma_f32_16x16x32_bf16 v[244:247], v[204:207], v[20:23], v[244:247]
    v_mfma_f32_16x16x32_bf16 v[248:251], v[204:207], v[24:27], v[248:251]
    v_mfma_f32_16x16x32_bf16 v[252:255], v[204:207], v[28:31], v[252:255]
    s_waitcnt vmcnt(6) lgkmcnt(0)
    v_mfma_f32_16x16x32_bf16 v[224:227], v[208:211], v[32:35], v[224:227]
    ds_read_b64_tr_b16 v[16:17], v12 offset:16384
    ds_read_b64_tr_b16 v[18:19], v12 offset:18432
    ds_read_b64_tr_b16 v[20:21], v13 offset:16384
    v_mfma_f32_16x16x32_bf16 v[228:231], v[208:211], v[36:39], v[228:231]
    ds_read_b64_tr_b16 v[22:23], v13 offset:18432
    ds_read_b64_tr_b16 v[24:25], v14 offset:16384
    ds_read_b64_tr_b16 v[26:27], v14 offset:18432
    v_mfma_f32_16x16x32_bf16 v[232:235], v[208:211], v[40:43], v[232:235]
    ds_read_b64_tr_b16 v[28:29], v15 offset:16384
    ds_read_b64_tr_b16 v[30:31], v15 offset:18432
    v_mfma_f32_16x16x32_bf16 v[236:239], v[208:211], v[44:47], v[236:239]
    buffer_load_dwordx4 v[200:203], v60, s[60:63], s17 offen sc1
    buffer_load_dwordx4 v[204:207], v61, s[60:63], s17 offen sc1
    s_add_u32 s17, s17, 3072
    s_cmp_ge_u32 s17, 49152
    s_cselect_b32 s6, 49152, 0
    s_sub_u32 s17, s17, s6
    v_mfma_f32_16x16x32_bf16 v[240:243], v[212:215], v[32:35], v[240:243]
    v_mfma_f32_16x16x32_bf16 v[244:247], v[212:215], v[36:39], v[244:247]
    v_mfma_f32_16x16x32_bf16 v[248:251], v[212:215], v[40:43], v[248:251]
    v_mfma_f32_16x16x32_bf16 v[252:255], v[212:215], v[44:47], v[252:255]
    s_waitcnt vmcnt(6) lgkmcnt(0)
    v_mfma_f32_16x16x32_bf16 v[224:227], v[216:219], v[16:19], v[224:227]
    buffer_load_dwordx4 v[208:211], v60, s[60:63], s17 offen sc1
    buffer_load_dwordx4 v[212:215], v61, s[60:63], s17 offen sc1
    s_add_u32 s17, s17, 8192
    s_cmp_ge_u32 s17, 49152
    s_cselect_b32 s6, 49152, 0
    s_sub_u32 s17, s17, s6
    v_mfma_f32_16x16x32_bf16 v[228:231], v[216:219], v[20:23], v[228:231]
    v_mfma_f32_16x16x32_bf16 v[232:235], v[216:219], v[24:27], v[232:235]
    v_mfma_f32_16x16x32_bf16 v[236:239], v[216:219], v[28:31], v[236:239]
    v_mfma_f32_16x16x32_bf16 v[240:243], v[220:223], v[16:19], v[240:243]
    v_mfma_f32_16x16x32_bf16 v[244:247], v[220:223], v[20:23], v[244:247]
    v_mfma_f32_16x16x32_bf16 v[248:251], v[220:223], v[24:27], v[248:251]
    v_mfma_f32_16x16x32_bf16 v[252:255], v[220:223], v[28:31], v[252:255]
    s_waitcnt vmcnt(6)
    v_mfma_f32_16x16x32_bf16 v[224:227], v[4:7], v[64:67], v[224:227]
    buffer_load_dwordx4 v[216:219], v60, s[60:63], s17 offen sc1
    buffer_load_dwordx4 v[220:223], v61, s[60:63], s17 offen sc1
    s_add_u32 s17, s17, 8192
    s_cmp_ge_u32 s17, 49152
    s_cselect_b32 s6, 49152, 0
    s_sub_u32 s17, s17, s6
    v_mfma_f32_16x16x32_bf16 v[228:231], v[4:7], v[68:71], v[228:231]
    v_mfma_f32_16x16x32_bf16 v[232:235], v[4:7], v[72:75], v[232:235]
    v_mfma_f32_16x16x32_bf16 v[236:239], v[4:7], v[76:79], v[236:239]
    v_mfma_f32_16x16x32_bf16 v[240:243], v[8:11], v[64:67], v[240:243]
    v_mfma_f32_16x16x32_bf16 v[244:247], v[8:11], v[68:71], v[244:247]
    v_mfma_f32_16x16x32_bf16 v[248:251], v[8:11], v[72:75], v[248:251]
    buffer_load_dwordx4 v[32:35], v60, s[60:63], s17 offen sc1
    buffer_load_dwordx4 v[36:39], v61, s[60:63], s17 offen sc1
    s_add_u32 s17, s17, 3072
    s_cmp_ge_u32 s17, 49152
    s_cselect_b32 s6, 49152, 0
    s_sub_u32 s17, s17, s6
    v_mfma_f32_16x16x32_bf16 v[252:255], v[8:11], v[76:79], v[252:255]
    s_waitcnt vmcnt(8)
    v_mfma_f32_16x16x32_bf16 v[224:227], v[192:195], v[80:83], v[224:227]
    buffer_load_dwordx4 v[40:43], v60, s[60:63], s17 offen sc1
    buffer_load_dwordx4 v[44:47], v61, s[60:63], s17 offen sc1
    s_add_u32 s17, s17, 8192
    s_cmp_ge_u32 s17, 49152
    s_cselect_b32 s6, 49152, 0
    s_sub_u32 s17, s17, s6
    v_mfma_f32_16x16x32_bf16 v[228:231], v[192:195], v[84:87], v[228:231]
    v_mfma_f32_16x16x32_bf16 v[232:235], v[192:195], v[88:91], v[232:235]
    v_mfma_f32_16x16x32_bf16 v[236:239], v[192:195], v[92:95], v[236:239]
    v_mfma_f32_16x16x32_bf16 v[240:243], v[196:199], v[80:83], v[240:243]
    v_mfma_f32_16x16x32_bf16 v[244:247], v[196:199], v[84:87], v[244:247]
    v_mfma_f32_16x16x32_bf16 v[248:251], v[196:199], v[88:91], v[248:251]
    v_mfma_f32_16x16x32_bf16 v[252:255], v[196:199], v[92:95], v[252:255]
    s_waitcnt vmcnt(8)
    v_mfma_f32_16x16x32_bf16 v[224:227], v[200:203], v[96:99], v[224:227]
    buffer_load_dwordx4 v[16:19], v60, s[60:63], s17 offen sc1
    buffer_load_dwordx4 v[20:23], v61, s[60:63], s17 offen sc1
    v_mfma_f32_16x16x32_bf16 v[228:231], v[200:203], v[100:103], v[228:231]
    v_mfma_f32_16x16x32_bf16 v[232:235], v[200:203], v[104:107], v[232:235]
    v_mfma_f32_16x16x32_bf16 v[236:239], v[200:203], v[108:111], v[236:239]
    v_mfma_f32_16x16x32_bf16 v[240:243], v[204:207], v[96:99], v[240:243]
    s_load_dwordx8 s[20:27], s[46:47], s37
    s_load_dword s28, s[46:47], s38
    v_mfma_f32_16x16x32_bf16 v[244:247], v[204:207], v[100:103], v[244:247]
    v_mfma_f32_16x16x32_bf16 v[248:251], v[204:207], v[104:107], v[248:251]
    v_mfma_f32_16x16x32_bf16 v[252:255], v[204:207], v[108:111], v[252:255]
    s_waitcnt vmcnt(8)
    v_mfma_f32_16x16x32_bf16 v[224:227], v[208:211], v[112:115], v[224:227]
    v_mfma_f32_16x16x32_bf16 v[228:231], v[208:211], v[116:119], v[228:231]
    v_mfma_f32_16x16x32_bf16 v[232:235], v[208:211], v[120:123], v[232:235]
    v_mfma_f32_16x16x32_bf16 v[236:239], v[208:211], v[124:127], v[236:239]
    v_mfma_f32_16x16x32_bf16 v[240:243], v[212:215], v[112:115], v[240:243]
    v_mfma_f32_16x16x32_bf16 v[244:247], v[212:215], v[116:119], v[244:247]
    v_mfma_f32_16x16x32_bf16 v[248:251], v[212:215], v[120:123], v[248:251]
    v_mfma_f32_16x16x32_bf16 v[252:255], v[212:215], v[124:127], v[252:255]
    s_waitcnt vmcnt(6) lgkmcnt(0)
    s_and_b64 s[20:21], s[20:21], s[22:23]
    s_and_b64 s[24:25], s[24:25], s[26:27]
    s_and_b32 s20, s20, s28
    s_and_b64 s[20:21], s[20:21], s[24:25]
    s_and_b32 s20, s20, s21
    s_cselect_b32 s18, 1, 0
    s_cselect_b64 exec, -1, 0
    s_mov_b32 s6, 0
    buffer_load_dwordx2 v[48:49], v55, s[64:67], s6 offen sc1
    s_mov_b32 s6, 65536
    buffer_load_dwordx2 v[50:51], v55, s[64:67], s6 offen sc1
    s_mov_b32 s6, 131072
    buffer_load_dwordx2 v[52:53], v55, s[64:67], s6 offen sc1
    s_mov_b32 s6, 196608
    buffer_load_dwordx2 v[54:55], v55, s[64:67], s6 offen sc1
    buffer_load_dwordx4 v[56:59], v56, s[68:71], 0 offen sc1
    s_mov_b64 exec, -1
    v_mfma_f32_16x16x32_bf16 v[224:227], v[216:219], v[128:131], v[224:227]
    v_mfma_f32_16x16x32_bf16 v[228:231], v[216:219], v[132:135], v[228:231]
    v_mfma_f32_16x16x32_bf16 v[232:235], v[216:219], v[136:139], v[232:235]
    v_mfma_f32_16x16x32_bf16 v[236:239], v[216:219], v[140:143], v[236:239]
    v_mfma_f32_16x16x32_bf16 v[240:243], v[220:223], v[128:131], v[240:243]
    v_mfma_f32_16x16x32_bf16 v[244:247], v[220:223], v[132:135], v[244:247]
    v_mfma_f32_16x16x32_bf16 v[248:251], v[220:223], v[136:139], v[248:251]
    v_mfma_f32_16x16x32_bf16 v[252:255], v[220:223], v[140:143], v[252:255]
    s_waitcnt vmcnt(9)
    v_mfma_f32_16x16x32_bf16 v[224:227], v[32:35], v[144:147], v[224:227]
    v_mfma_f32_16x16x32_bf16 v[228:231], v[32:35], v[148:151], v[228:231]
    v_mfma_f32_16x16x32_bf16 v[232:235], v[32:35], v[152:155], v[232:235]
    v_mfma_f32_16x16x32_bf16 v[236:239], v[32:35], v[156:159], v[236:239]
    v_mfma_f32_16x16x32_bf16 v[240:243], v[36:39], v[144:147], v[240:243]
    v_mfma_f32_16x16x32_bf16 v[244:247], v[36:39], v[148:151], v[244:247]
    v_mfma_f32_16x16x32_bf16 v[248:251], v[36:39], v[152:155], v[248:251]
    v_mfma_f32_16x16x32_bf16 v[252:255], v[36:39], v[156:159], v[252:255]
    v_lshlrev_b32 v2, 4, v1
    s_and_b32 s12, s3, 3
    s_lshl_b32 s6, s12, 12
    s_add_u32 s7, s6, 73728
    s_add_u32 s6, s6, 94208
    v_add_u32 v3, s6, v2
    v_add_u32 v4, s7, v2
    s_lshl_b32 s6, s12, 10
    s_add_u32 s6, s6, 90112
    v_add_u32 v10, s6, v2
    v_and_b32 v5, 15, v1
    v_lshrrev_b32 v6, 4, v1
    v_lshrrev_b32 v7, 2, v5
    v_xor_b32 v7, v7, v6
    v_lshlrev_b32 v7, 3, v7
    v_lshl_add_u32 v7, v5, 5, v7
    v_add_u32 v7, s7, v7
    v_lshlrev_b32 v8, 1, v6
    v_xor_b32 v8, v8, v1
    v_and_b32 v8, 3, v8
    v_lshlrev_b32 v8, 3, v8
    v_bfe_u32 v9, v1, 2, 2
    v_lshl_add_u32 v9, v6, 3, v9
    v_lshl_add_u32 v8, v9, 5, v8
    v_add_u32 v8, s7, v8
    v_xor_b32 v9, 8, v8
    v_add_u32 v5, s16, v5
    s_movk_i32 s6, 1280
    v_mul_u32_u24 v5, s6, v5
    v_lshl_add_u32 v5, v6, 4, v5
    s_lshl_b32 s6, s11, 7
    v_add_u32 v5, s6, v5
    s_waitcnt vmcnt(7)
    v_mfma_f32_16x16x32_bf16 v[224:227], v[40:43], v[160:163], v[224:227]
    v_mfma_f32_16x16x32_bf16 v[228:231], v[40:43], v[164:167], v[228:231]
    v_mfma_f32_16x16x32_bf16 v[232:235], v[40:43], v[168:171], v[232:235]
    v_mfma_f32_16x16x32_bf16 v[236:239], v[40:43], v[172:175], v[236:239]
    v_mfma_f32_16x16x32_bf16 v[240:243], v[44:47], v[160:163], v[240:243]
    v_mfma_f32_16x16x32_bf16 v[244:247], v[44:47], v[164:167], v[244:247]
    v_mfma_f32_16x16x32_bf16 v[248:251], v[44:47], v[168:171], v[248:251]
    v_mfma_f32_16x16x32_bf16 v[252:255], v[44:47], v[172:175], v[252:255]
    s_waitcnt vmcnt(5)
    s_barrier
    v_mfma_f32_16x16x32_bf16 v[224:227], v[16:19], v[176:179], v[224:227]
    v_mfma_f32_16x16x32_bf16 v[228:231], v[16:19], v[180:183], v[228:231]
    v_mfma_f32_16x16x32_bf16 v[232:235], v[16:19], v[184:187], v[232:235]
    v_mfma_f32_16x16x32_bf16 v[236:239], v[16:19], v[188:191], v[236:239]
    v_mfma_f32_16x16x32_bf16 v[240:243], v[20:23], v[176:179], v[240:243]
    v_mfma_f32_16x16x32_bf16 v[244:247], v[20:23], v[180:183], v[244:247]
    v_mfma_f32_16x16x32_bf16 v[248:251], v[20:23], v[184:187], v[248:251]
    v_mfma_f32_16x16x32_bf16 v[252:255], v[20:23], v[188:191], v[252:255]
    s_nop 0
    ds_write_b128 v3, v[224:227] offset:0
    ds_write_b128 v3, v[228:231] offset:1024
    ds_write_b128 v3, v[232:235] offset:2048
    ds_write_b128 v3, v[236:239] offset:3072
    ds_read_b128 v[64:67], v4 offset:0
    ds_read_b128 v[68:71], v4 offset:1024
    ds_read_b128 v[72:75], v4 offset:2048
    ds_read_b128 v[76:79], v4 offset:3072
    s_waitcnt lgkmcnt(4)
    s_barrier
    s_cmp_lg_u32 s18, 0
    s_cbranch_scc1 EPK_3
POLL_4:
    buffer_load_dword v58, v57, s[68:71], 0 offen sc1
    s_waitcnt vmcnt(0)
    v_cmp_ne_u32 vcc, 1, v58
    s_cbranch_vccnz POLL_4
POLLD_5:
    s_mov_b32 s6, 0
    buffer_load_dwordx2 v[48:49], v55, s[64:67], s6 offen sc1
    s_mov_b32 s6, 65536
    buffer_load_dwordx2 v[50:51], v55, s[64:67], s6 offen sc1
    s_mov_b32 s6, 131072
    buffer_load_dwordx2 v[52:53], v55, s[64:67], s6 offen sc1
    s_mov_b32 s6, 196608
    buffer_load_dwordx2 v[54:55], v55, s[64:67], s6 offen sc1
    buffer_load_dwordx4 v[56:59], v56, s[68:71], 0 offen sc1
EPK_3:
    s_waitcnt vmcnt(0)
    v_lshlrev_b32 v28, 16, v56
    v_and_b32 v24, 0xffff0000, v56
    v_lshlrev_b32 v29, 16, v57
    v_and_b32 v25, 0xffff0000, v57
    v_lshlrev_b32 v30, 16, v58
    v_and_b32 v26, 0xffff0000, v58
    v_lshlrev_b32 v31, 16, v59
    v_and_b32 v27, 0xffff0000, v59
    v_lshlrev_b32 v96, 16, v48
    v_and_b32 v97, 0xffff0000, v48
    v_lshlrev_b32 v98, 16, v49
    v_and_b32 v99, 0xffff0000, v49
    v_lshlrev_b32 v100, 16, v50
    v_and_b32 v101, 0xffff0000, v50
    v_lshlrev_b32 v102, 16, v51
    v_and_b32 v103, 0xffff0000, v51
    v_lshlrev_b32 v104, 16, v52
    v_and_b32 v105, 0xffff0000, v52
    v_lshlrev_b32 v106, 16, v53
    v_and_b32 v107, 0xffff0000, v53
    v_lshlrev_b32 v108, 16, v54
    v_and_b32 v109, 0xffff0000, v54
    v_lshlrev_b32 v110, 16, v55
    v_and_b32 v111, 0xffff0000, v55
    v_pk_mul_f32 v[96:97], v[28:29], v[96:97]
    v_pk_mul_f32 v[98:99], v[30:31], v[98:99]
    v_pk_mul_f32 v[100:101], v[28:29], v[100:101]
    v_pk_mul_f32 v[102:103], v[30:31], v[102:103]
    v_pk_mul_f32 v[104:105], v[28:29], v[104:105]
    v_pk_mul_f32 v[106:107], v[30:31], v[106:107]
    v_pk_mul_f32 v[108:109], v[28:29], v[108:109]
    v_pk_mul_f32 v[110:111], v[30:31], v[110:111]
    v_pk_fma_f32 v[96:97], v[24:25], v[240:241], v[96:97]
    v_pk_fma_f32 v[98:99], v[26:27], v[242:243], v[98:99]
    v_pk_fma_f32 v[100:101], v[24:25], v[244:245], v[100:101]
    v_pk_fma_f32 v[102:103], v[26:27], v[246:247], v[102:103]
    v_pk_fma_f32 v[104:105], v[24:25], v[248:249], v[104:105]
    v_pk_fma_f32 v[106:107], v[26:27], v[250:251], v[106:107]
    v_pk_fma_f32 v[108:109], v[24:25], v[252:253], v[108:109]
    v_pk_fma_f32 v[110:111], v[26:27], v[254:255], v[110:111]
    s_waitcnt lgkmcnt(3)
    v_pk_fma_f32 v[64:65], v[24:25], v[64:65], v[96:97]
    v_pk_fma_f32 v[66:67], v[26:27], v[66:67], v[98:99]
    v_cvt_pk_bf16_f32 v80, v64, v65
    v_cvt_pk_bf16_f32 v81, v66, v67
    ds_write_b64 v7, v[80:81] offset:0
    s_waitcnt lgkmcnt(3)
    v_pk_fma_f32 v[68:69], v[24:25], v[68:69], v[100:101]
    v_pk_fma_f32 v[70:71], v[26:27], v[70:71], v[102:103]
    v_cvt_pk_bf16_f32 v82, v68, v69
    v_cvt_pk_bf16_f32 v83, v70, v71
    ds_write_b64 v7, v[82:83] offset:512
    s_waitcnt lgkmcnt(3)
    v_pk_fma_f32 v[72:73], v[24:25], v[72:73], v[104:105]
    v_pk_fma_f32 v[74:75], v[26:27], v[74:75], v[106:107]
    v_cvt_pk_bf16_f32 v84, v72, v73
    v_cvt_pk_bf16_f32 v85, v74, v75
    ds_write_b64 v7, v[84:85] offset:1024
    s_waitcnt lgkmcnt(3)
    v_pk_fma_f32 v[76:77], v[24:25], v[76:77], v[108:109]
    v_pk_fma_f32 v[78:79], v[26:27], v[78:79], v[110:111]
    v_cvt_pk_bf16_f32 v86, v76, v77
    v_cvt_pk_bf16_f32 v87, v78, v79
    ds_write_b64 v7, v[86:87] offset:1536
    ds_read_b64_tr_b16 v[16:17], v8 offset:0
    ds_read_b64_tr_b16 v[18:19], v9 offset:128
    ds_read_b64_tr_b16 v[20:21], v8 offset:1024
    ds_read_b64_tr_b16 v[22:23], v9 offset:1152
    s_waitcnt lgkmcnt(2)
    buffer_store_dwordx4 v[16:19], v5, s[72:75], 0 offen
    s_waitcnt lgkmcnt(0)
    buffer_store_dwordx4 v[20:23], v5, s[72:75], 0 offen offset:64
    s_endpgm
LNR_1:
RDY_6:
    buffer_load_dword v20, v21, s[76:79], 0 offen sc1
    s_waitcnt vmcnt(0)
    v_cmp_eq_u32 vcc, 1, v20
    s_cbranch_vccz RDY_6
RDYD_7:
    s_branch LRD_2
L_G1C:
    v_lshrrev_b32 v6, 4, v1
    v_bfe_u32 v7, v1, 2, 2
    v_lshl_add_u32 v8, v6, 3, v7
    s_movk_i32 s6, 320
    v_mul_u32_u24 v8, s6, v8
    v_and_b32 v9, 1, v6
    v_lshl_add_u32 v8, v9, 5, v8
    v_and_b32 v9, 3, v1
    v_lshl_add_u32 v8, v9, 3, v8
    v_add_u32 v2, 16384, v8
    v_xor_b32 v3, 32, v2
    v_and_b32 v8, 15, v1
    v_lshrrev_b32 v9, 1, v8
    v_xor_b32 v9, v9, v6
    v_lshlrev_b32 v9, 4, v9
    v_lshl_add_u32 v9, v8, 7, v9
    s_lshl_b32 s6, s3, 12
    v_add_u32 v4, s6, v9
    v_xor_b32 v5, 64, v4
    s_lshl_b32 s6, s10, 3
    s_lshl_b32 s7, s3, 1
    s_add_u32 s6, s6, s7
    s_mul_i32 s6, s6, 48
    s_add_u32 s6, s6, s9
    s_lshl_b32 s6, s6, 10
    v_lshl_add_u32 v11, v1, 4, s6
    s_cmp_eq_u32 s11, 9
    s_cselect_b32 s84, 0x10000000, 0
    s_cselect_b32 s7, 16, 0
    v_min_u32 v54, 39, v1
    v_max_u32 v54, s7, v54
    v_lshl_add_u32 v54, v54, 7, s6
    s_add_u32 s85, s84, 49152
    s_movk_i32 s86, 2048
    s_mov_b32 s87, 51200
    s_mov_b32 s14, 0
    s_mov_b32 s82, 36864
    s_mov_b32 s15, 9
    s_lshl_b32 s6, s10, 2
    s_add_u32 s6, s6, s3
    s_mul_i32 s6, s6, 160
    s_add_u32 s6, s6, s11
    s_lshl_b32 s6, s6, 2
    s_add_u32 s6, s6, 0x4000
    v_min_u32 v52, 9, v1
    v_lshl_add_u32 v52, v52, 6, s6
    v_mov_b32 v53, 1
    s_waitcnt lgkmcnt(0)
    s_mov_b32 s56, s38
    s_mov_b32 s57, s39
    s_mov_b32 s58, 0x1e0000
    s_mov_b32 s59, 0x20000
    s_mov_b32 s60, s46
    s_mov_b32 s61, s47
    s_mov_b32 s62, 0x600000
    s_mov_b32 s63, 0x20000
    s_add_u32 s68, s46, 0x880000
    s_addc_u32 s69, s47, 0
    s_mov_b32 s70, 0x10000
    s_mov_b32 s71, 0x20000
    s_add_u32 s64, s46, 0x600000
    s_addc_u32 s65, s47, 0
    s_mov_b32 s66, 0x280000
    s_mov_b32 s67, 0x20000
    s_mov_b32 s72, s42
    s_mov_b32 s73, s43
    s_mov_b32 s74, 0x280000
    s_mov_b32 s75, 0x20000
    v_lshrrev_b32 v12, 2, v1
    v_bfe_u32 v8, v1, 3, 2
    v_lshlrev_b32 v12, 7, v12
    v_lshl_or_b32 v12, v8, 5, v12
    v_and_b32 v8, 3, v1
    v_lshl_or_b32 v12, v8, 3, v12
    v_add_u32 v12, 73728, v12
    v_xor_b32 v13, 32, v12
    v_xor_b32 v14, 64, v12
    v_xor_b32 v15, 96, v12
    s_and_b32 s19, s3, 3
    s_lshl_b32 s6, s10, 3
    s_lshl_b32 s7, s19, 1
    s_add_u32 s16, s6, s7
    s_mul_i32 s6, s16, 49152
    v_lshl_add_u32 v60, v1, 4, s6
    v_add_u32 v61, 49152, v60
    s_lshl_b32 s7, s9, 3
    s_add_u32 s7, s7, 40
    v_min_u32 v59, 39, v1
    v_add_u32 v59, s7, v59
    v_subrev_u32 v58, 384, v59
    v_min_u32 v59, v59, v58
    v_lshl_add_u32 v59, v59, 7, s6
    s_add_u32 s17, s9, 11
    s_cmp_ge_u32 s17, 48
    s_cselect_b32 s6, 48, 0
    s_sub_u32 s17, s17, s6
    s_lshl_b32 s17, s17, 10
    s_lshl_b32 s6, s10, 2
    s_add_u32 s6, s6, s19
    s_mul_i32 s6, s6, 10
    s_add_u32 s6, s6, s11
    s_mul_i32 s6, s6, 64
    s_add_u32 s36, s6, 0x884000
    s_lshl_b32 s6, s11, 7
    s_add_u32 s37, s6, 0x88e000
    s_lshl_b32 s6, s10, 7
    s_add_u32 s38, s6, 0x88e800
    s_add_u32 s16, s16, 0
    s_lshl_b32 s16, s16, 4
    v_lshrrev_b32 v56, 2, v1
    v_and_b32 v56, 12, v56
    v_add_u32 v56, s16, v56
    v_and_b32 v57, 15, v1
    s_lshl_b32 s6, s11, 6
    v_add_u32 v57, s6, v57
    v_mul_u32_u24 v57, 4096, v57
    v_lshl_add_u32 v55, v56, 1, v57
    v_lshlrev_b32 v56, 2, v56
    s_sub_u32 s6, s37, 0x880000
    s_sub_u32 s7, s38, 0x880000
    v_lshl_add_u32 v57, v1, 2, s6
    v_mov_b32 v48, s7
    v_cmp_gt_u32 vcc, 8, v1
    s_nop 1
    v_cndmask_b32 v57, v48, v57, vcc
    s_barrier
    ds_read_b128 v[16:19], v4 offset:0
    ds_read_b128 v[20:23], v4 offset:2048
    ds_read_b64_tr_b16 v[64:65], v2 offset:0
    ds_read_b64_tr_b16 v[66:67], v2 offset:1280
    ds_read_b64_tr_b16 v[68:69], v3 offset:0
    ds_read_b64_tr_b16 v[70:71], v3 offset:1280
    ds_read_b64_tr_b16 v[72:73], v2 offset:64
    ds_read_b64_tr_b16 v[74:75], v2 offset:1344
    ds_read_b64_tr_b16 v[76:77], v3 offset:64
    ds_read_b64_tr_b16 v[78:79], v3 offset:1344
    ds_read_b64_tr_b16 v[80:81], v2 offset:128
    ds_read_b64_tr_b16 v[82:83], v2 offset:1408
    ds_read_b64_tr_b16 v[84:85], v3 offset:128
    ds_read_b64_tr_b16 v[86:87], v3 offset:1408
    s_waitcnt lgkmcnt(8)
    v_mfma_f32_16x16x32_bf16 v[144:147], v[64:67], v[16:19], 0
    ds_read_b64_tr_b16 v[88:89], v2 offset:192
    ds_read_b64_tr_b16 v[90:91], v2 offset:1472
    s_add_u32 s14, s14, 36864
    v_mfma_f32_16x16x32_bf16 v[148:151], v[68:71], v[16:19], 0
    ds_read_b64_tr_b16 v[92:93], v3 offset:192
    ds_read_b64_tr_b16 v[94:95], v3 offset:1472
    s_cmp_ge_u32 s14, 147456
    v_mfma_f32_16x16x32_bf16 v[152:155], v[64:67], v[20:23], 0
    ds_read_b64_tr_b16 v[96:97], v2 offset:256
    ds_read_b64_tr_b16 v[98:99], v2 offset:1536
    s_cselect_b32 s6, 4294856704, s82
    v_mfma_f32_16x16x32_bf16 v[156:159], v[68:71], v[20:23], 0
    ds_read_b64_tr_b16 v[100:101], v3 offset:256
    ds_read_b64_tr_b16 v[102:103], v3 offset:1536
    s_cselect_b32 s14, 0, s14
    s_waitcnt lgkmcnt(12)
    v_mfma_f32_16x16x32_bf16 v[160:163], v[72:75], v[16:19], 0
    ds_read_b128 v[24:27], v5 offset:0
    v_mfma_f32_16x16x32_bf16 v[164:167], v[76:79], v[16:19], 0
    ds_read_b128 v[28:31], v5 offset:2048
    ds_read_b64_tr_b16 v[104:105], v2 offset:10240
    v_mfma_f32_16x16x32_bf16 v[168:171], v[72:75], v[20:23], 0
    ds_read_b64_tr_b16 v[106:107], v2 offset:11520
    ds_read_b64_tr_b16 v[108:109], v3 offset:10240
    v_mfma_f32_16x16x32_bf16 v[172:175], v[76:79], v[20:23], 0
    ds_read_b64_tr_b16 v[110:111], v3 offset:11520
    ds_read_b64_tr_b16 v[112:113], v2 offset:10304
    s_waitcnt lgkmcnt(15)
    v_mfma_f32_16x16x32_bf16 v[176:179], v[80:83], v[16:19], 0
    ds_read_b64_tr_b16 v[114:115], v2 offset:11584
    v_mfma_f32_16x16x32_bf16 v[180:183], v[84:87], v[16:19], 0
    ds_read_b64_tr_b16 v[116:117], v3 offset:10304
    ds_read_b64_tr_b16 v[118:119], v3 offset:11584
    v_mfma_f32_16x16x32_bf16 v[184:187], v[80:83], v[20:23], 0
    ds_read_b64_tr_b16 v[120:121], v2 offset:10368
    ds_read_b64_tr_b16 v[122:123], v2 offset:11648
    v_mfma_f32_16x16x32_bf16 v[188:191], v[84:87], v[20:23], 0
    ds_read_b64_tr_b16 v[124:125], v3 offset:10368
    ds_read_b64_tr_b16 v[126:127], v3 offset:11648
    s_waitcnt lgkmcnt(15)
    v_mfma_f32_16x16x32_bf16 v[192:195], v[88:91], v[16:19], 0
    ds_read_b64_tr_b16 v[128:129], v2 offset:10432
    v_mfma_f32_16x16x32_bf16 v[196:199], v[92:95], v[16:19], 0
    ds_read_b64_tr_b16 v[130:131], v2 offset:11712
    ds_read_b64_tr_b16 v[132:133], v3 offset:10432
    v_mfma_f32_16x16x32_bf16 v[200:203], v[88:91], v[20:23], 0
    ds_read_b64_tr_b16 v[134:135], v3 offset:11712
    ds_read_b64_tr_b16 v[136:137], v2 offset:10496
    v_mfma_f32_16x16x32_bf16 v[204:207], v[92:95], v[20:23], 0
    ds_read_b64_tr_b16 v[138:139], v2 offset:11776
    ds_read_b64_tr_b16 v[140:141], v3 offset:10496
    s_waitcnt lgkmcnt(15)
    v_mfma_f32_16x16x32_bf16 v[208:211], v[96:99], v[16:19], 0
    ds_read_b64_tr_b16 v[142:143], v3 offset:11776
    v_mfma_f32_16x16x32_bf16 v[212:215], v[100:103], v[16:19], 0
    v_add_u32 v2, s6, v2
    v_add_u32 v3, s6, v3
    v_mfma_f32_16x16x32_bf16 v[216:219], v[96:99], v[20:23], 0
    v_add_u32 v4, s6, v4
    v_add_u32 v5, s6, v5
    v_mfma_f32_16x16x32_bf16 v[220:223], v[100:103], v[20:23], 0
G1C_8:
    s_waitcnt lgkmcnt(0)
    s_barrier
    v_mfma_f32_16x16x32_bf16 v[144:147], v[104:107], v[24:27], v[144:147]
    ds_read_b128 v[16:19], v4 offset:0
    ds_read_b128 v[20:23], v4 offset:2048
    v_mfma_f32_16x16x32_bf16 v[148:151], v[108:111], v[24:27], v[148:151]
    ds_read_b64_tr_b16 v[64:65], v2 offset:0
    v_mfma_f32_16x16x32_bf16 v[152:155], v[104:107], v[28:31], v[152:155]
    ds_read_b64_tr_b16 v[66:67], v2 offset:1280
    s_sub_u32 s15, s15, 1
    v_mfma_f32_16x16x32_bf16 v[156:159], v[108:111], v[28:31], v[156:159]
    ds_read_b64_tr_b16 v[68:69], v3 offset:0
    ds_read_b64_tr_b16 v[70:71], v3 offset:1280
    v_mfma_f32_16x16x32_bf16 v[160:163], v[112:115], v[24:27], v[160:163]
    ds_read_b64_tr_b16 v[72:73], v2 offset:64
    s_add_u32 s14, s14, 36864
    v_mfma_f32_16x16x32_bf16 v[164:167], v[116:119], v[24:27], v[164:167]
    ds_read_b64_tr_b16 v[74:75], v2 offset:1344
    s_cmp_ge_u32 s14, 147456
    v_mfma_f32_16x16x32_bf16 v[168:171], v[112:115], v[28:31], v[168:171]
    ds_read_b64_tr_b16 v[76:77], v3 offset:64
    s_cselect_b32 s6, 4294856704, s82
    v_mfma_f32_16x16x32_bf16 v[172:175], v[116:119], v[28:31], v[172:175]
    ds_read_b64_tr_b16 v[78:79], v3 offset:1344
    ds_read_b64_tr_b16 v[80:81], v2 offset:128
    v_mfma_f32_16x16x32_bf16 v[176:179], v[120:123], v[24:27], v[176:179]
    ds_read_b64_tr_b16 v[82:83], v2 offset:1408
    s_cselect_b32 s14, 0, s14
    v_mfma_f32_16x16x32_bf16 v[180:183], v[124:127], v[24:27], v[180:183]
    ds_read_b64_tr_b16 v[84:85], v3 offset:128
    s_cmp_lg_u32 s15, 0
    v_mfma_f32_16x16x32_bf16 v[184:187], v[120:123], v[28:31], v[184:187]
    ds_read_b64_tr_b16 v[86:87], v3 offset:1408
    v_mfma_f32_16x16x32_bf16 v[188:191], v[124:127], v[28:31], v[188:191]
    ds_read_b64_tr_b16 v[88:89], v2 offset:192
    ds_read_b64_tr_b16 v[90:91], v2 offset:1472
    v_mfma_f32_16x16x32_bf16 v[192:195], v[128:131], v[24:27], v[192:195]
    ds_read_b64_tr_b16 v[92:93], v3 offset:192
    v_mfma_f32_16x16x32_bf16 v[196:199], v[132:135], v[24:27], v[196:199]
    ds_read_b64_tr_b16 v[94:95], v3 offset:1472
    v_mfma_f32_16x16x32_bf16 v[200:203], v[128:131], v[28:31], v[200:203]
    ds_read_b64_tr_b16 v[96:97], v2 offset:256
    v_mfma_f32_16x16x32_bf16 v[204:207], v[132:135], v[28:31], v[204:207]
    ds_read_b64_tr_b16 v[98:99], v2 offset:1536
    ds_read_b64_tr_b16 v[100:101], v3 offset:256
    v_mfma_f32_16x16x32_bf16 v[208:211], v[136:139], v[24:27], v[208:211]
    ds_read_b64_tr_b16 v[102:103], v3 offset:1536
    v_mfma_f32_16x16x32_bf16 v[212:215], v[140:143], v[24:27], v[212:215]
    ds_read_b64_tr_b16 v[104:105], v2 offset:10240
    v_mfma_f32_16x16x32_bf16 v[216:219], v[136:139], v[28:31], v[216:219]
    ds_read_b64_tr_b16 v[106:107], v2 offset:11520
    v_mfma_f32_16x16x32_bf16 v[220:223], v[140:143], v[28:31], v[220:223]
    ds_read_b64_tr_b16 v[108:109], v3 offset:10240
    ds_read_b64_tr_b16 v[110:111], v3 offset:11520
    s_waitcnt lgkmcnt(15)
    v_mfma_f32_16x16x32_bf16 v[144:147], v[64:67], v[16:19], v[144:147]
    ds_read_b128 v[24:27], v5 offset:0
    v_mfma_f32_16x16x32_bf16 v[148:151], v[68:71], v[16:19], v[148:151]
    ds_read_b128 v[28:31], v5 offset:2048
    v_mfma_f32_16x16x32_bf16 v[152:155], v[64:67], v[20:23], v[152:155]
    ds_read_b64_tr_b16 v[112:113], v2 offset:10304
    v_mfma_f32_16x16x32_bf16 v[156:159], v[68:71], v[20:23], v[156:159]
    ds_read_b64_tr_b16 v[114:115], v2 offset:11584
    ds_read_b64_tr_b16 v[116:117], v3 offset:10304
    v_mfma_f32_16x16x32_bf16 v[160:163], v[72:75], v[16:19], v[160:163]
    ds_read_b64_tr_b16 v[118:119], v3 offset:11584
    v_mfma_f32_16x16x32_bf16 v[164:167], v[76:79], v[16:19], v[164:167]
    ds_read_b64_tr_b16 v[120:121], v2 offset:10368
    v_mfma_f32_16x16x32_bf16 v[168:171], v[72:75], v[20:23], v[168:171]
    ds_read_b64_tr_b16 v[122:123], v2 offset:11648
    v_mfma_f32_16x16x32_bf16 v[172:175], v[76:79], v[20:23], v[172:175]
    ds_read_b64_tr_b16 v[124:125], v3 offset:10368
    ds_read_b64_tr_b16 v[126:127], v3 offset:11648
    s_waitcnt lgkmcnt(14)
    v_mfma_f32_16x16x32_bf16 v[176:179], v[80:83], v[16:19], v[176:179]
    ds_read_b64_tr_b16 v[128:129], v2 offset:10432
    v_mfma_f32_16x16x32_bf16 v[180:183], v[84:87], v[16:19], v[180:183]
    ds_read_b64_tr_b16 v[130:131], v2 offset:11712
    v_mfma_f32_16x16x32_bf16 v[184:187], v[80:83], v[20:23], v[184:187]
    ds_read_b64_tr_b16 v[132:133], v3 offset:10432
    v_mfma_f32_16x16x32_bf16 v[188:191], v[84:87], v[20:23], v[188:191]
    ds_read_b64_tr_b16 v[134:135], v3 offset:11712
    ds_read_b64_tr_b16 v[136:137], v2 offset:10496
    v_mfma_f32_16x16x32_bf16 v[192:195], v[88:91], v[16:19], v[192:195]
    ds_read_b64_tr_b16 v[138:139], v2 offset:11776
    v_mfma_f32_16x16x32_bf16 v[196:199], v[92:95], v[16:19], v[196:199]
    ds_read_b64_tr_b16 v[140:141], v3 offset:10496
    v_mfma_f32_16x16x32_bf16 v[200:203], v[88:91], v[20:23], v[200:203]
    ds_read_b64_tr_b16 v[142:143], v3 offset:11776
    v_mfma_f32_16x16x32_bf16 v[204:207], v[92:95], v[20:23], v[204:207]
    v_add_u32 v2, s6, v2
    v_mfma_f32_16x16x32_bf16 v[208:211], v[96:99], v[16:19], v[208:211]
    v_add_u32 v3, s6, v3
    v_mfma_f32_16x16x32_bf16 v[212:215], v[100:103], v[16:19], v[212:215]
    v_add_u32 v4, s6, v4
    v_mfma_f32_16x16x32_bf16 v[216:219], v[96:99], v[20:23], v[216:219]
    v_add_u32 v5, s6, v5
    v_mfma_f32_16x16x32_bf16 v[220:223], v[100:103], v[20:23], v[220:223]
    s_cbranch_scc1 G1C_8
    s_waitcnt lgkmcnt(0)
    v_mfma_f32_16x16x32_bf16 v[144:147], v[104:107], v[24:27], v[144:147]
    v_mfma_f32_16x16x32_bf16 v[148:151], v[108:111], v[24:27], v[148:151]
    v_mfma_f32_16x16x32_bf16 v[152:155], v[104:107], v[28:31], v[152:155]
    v_mfma_f32_16x16x32_bf16 v[156:159], v[108:111], v[28:31], v[156:159]
    v_mfma_f32_16x16x32_bf16 v[160:163], v[112:115], v[24:27], v[160:163]
    v_mfma_f32_16x16x32_bf16 v[164:167], v[116:119], v[24:27], v[164:167]
    v_mfma_f32_16x16x32_bf16 v[168:171], v[112:115], v[28:31], v[168:171]
    v_mfma_f32_16x16x32_bf16 v[172:175], v[116:119], v[28:31], v[172:175]
    s_nop 0
    v_cvt_pk_bf16_f32 v64, v144, v145
    v_cvt_pk_bf16_f32 v65, v146, v147
    v_cvt_pk_bf16_f32 v66, v148, v149
    v_cvt_pk_bf16_f32 v67, v150, v151
    v_pk_max_i16 v64, v64, 0
    v_pk_max_i16 v65, v65, 0
    v_pk_max_i16 v66, v66, 0
    v_pk_max_i16 v67, v67, 0
    buffer_store_dwordx4 v[64:67], v11, s[60:63], s84 offen offset:0 sc1
    v_mfma_f32_16x16x32_bf16 v[176:179], v[120:123], v[24:27], v[176:179]
    v_mfma_f32_16x16x32_bf16 v[180:183], v[124:127], v[24:27], v[180:183]
    v_cvt_pk_bf16_f32 v68, v152, v153
    v_cvt_pk_bf16_f32 v69, v154, v155
    v_cvt_pk_bf16_f32 v70, v156, v157
    v_cvt_pk_bf16_f32 v71, v158, v159
    v_pk_max_i16 v68, v68, 0
    v_pk_max_i16 v69, v69, 0
    v_pk_max_i16 v70, v70, 0
    v_pk_max_i16 v71, v71, 0
    buffer_store_dwordx4 v[68:71], v11, s[60:63], s85 offen offset:0 sc1
    v_mfma_f32_16x16x32_bf16 v[184:187], v[120:123], v[28:31], v[184:187]
    v_mfma_f32_16x16x32_bf16 v[188:191], v[124:127], v[28:31], v[188:191]
    v_cvt_pk_bf16_f32 v72, v160, v161
    v_cvt_pk_bf16_f32 v73, v162, v163
    v_cvt_pk_bf16_f32 v74, v164, v165
    v_cvt_pk_bf16_f32 v75, v166, v167
    v_pk_max_i16 v72, v72, 0
    v_pk_max_i16 v73, v73, 0
    v_pk_max_i16 v74, v74, 0
    v_pk_max_i16 v75, v75, 0
    buffer_store_dwordx4 v[72:75], v11, s[60:63], s84 offen offset:1024 sc1
    v_mfma_f32_16x16x32_bf16 v[192:195], v[128:131], v[24:27], v[192:195]
    v_mfma_f32_16x16x32_bf16 v[196:199], v[132:135], v[24:27], v[196:199]
    v_cvt_pk_bf16_f32 v76, v168, v169
    v_cvt_pk_bf16_f32 v77, v170, v171
    v_cvt_pk_bf16_f32 v78, v172, v173
    v_cvt_pk_bf16_f32 v79, v174, v175
    v_pk_max_i16 v76, v76, 0
    v_pk_max_i16 v77, v77, 0
    v_pk_max_i16 v78, v78, 0
    v_pk_max_i16 v79, v79, 0
    buffer_store_dwordx4 v[76:79], v11, s[60:63], s85 offen offset:1024 sc1
    v_mfma_f32_16x16x32_bf16 v[200:203], v[128:131], v[28:31], v[200:203]
    v_mfma_f32_16x16x32_bf16 v[204:207], v[132:135], v[28:31], v[204:207]
    v_cvt_pk_bf16_f32 v80, v176, v177
    v_cvt_pk_bf16_f32 v81, v178, v179
    v_cvt_pk_bf16_f32 v82, v180, v181
    v_cvt_pk_bf16_f32 v83, v182, v183
    v_pk_max_i16 v80, v80, 0
    v_pk_max_i16 v81, v81, 0
    v_pk_max_i16 v82, v82, 0
    v_pk_max_i16 v83, v83, 0
    buffer_store_dwordx4 v[80:83], v11, s[60:63], s86 offen offset:0 sc1
    v_mfma_f32_16x16x32_bf16 v[208:211], v[136:139], v[24:27], v[208:211]
    v_mfma_f32_16x16x32_bf16 v[212:215], v[140:143], v[24:27], v[212:215]
    v_cvt_pk_bf16_f32 v84, v184, v185
    v_cvt_pk_bf16_f32 v85, v186, v187
    v_cvt_pk_bf16_f32 v86, v188, v189
    v_cvt_pk_bf16_f32 v87, v190, v191
    v_pk_max_i16 v84, v84, 0
    v_pk_max_i16 v85, v85, 0
    v_pk_max_i16 v86, v86, 0
    v_pk_max_i16 v87, v87, 0
    buffer_store_dwordx4 v[84:87], v11, s[60:63], s87 offen offset:0 sc1
    v_mfma_f32_16x16x32_bf16 v[216:219], v[136:139], v[28:31], v[216:219]
    v_mfma_f32_16x16x32_bf16 v[220:223], v[140:143], v[28:31], v[220:223]
    v_cvt_pk_bf16_f32 v88, v192, v193
    v_cvt_pk_bf16_f32 v89, v194, v195
    v_cvt_pk_bf16_f32 v90, v196, v197
    v_cvt_pk_bf16_f32 v91, v198, v199
    v_pk_max_i16 v88, v88, 0
    v_pk_max_i16 v89, v89, 0
    v_pk_max_i16 v90, v90, 0
    v_pk_max_i16 v91, v91, 0
    buffer_store_dwordx4 v[88:91], v11, s[60:63], s86 offen offset:1024 sc1
    v_cvt_pk_bf16_f32 v92, v200, v201
    v_cvt_pk_bf16_f32 v93, v202, v203
    v_cvt_pk_bf16_f32 v94, v204, v205
    v_cvt_pk_bf16_f32 v95, v206, v207
    v_pk_max_i16 v92, v92, 0
    v_pk_max_i16 v93, v93, 0
    v_pk_max_i16 v94, v94, 0
    v_pk_max_i16 v95, v95, 0
    buffer_store_dwordx4 v[92:95], v11, s[60:63], s87 offen offset:1024 sc1
    v_cvt_pk_bf16_f32 v96, v208, v209
    v_cvt_pk_bf16_f32 v97, v210, v211
    v_cvt_pk_bf16_f32 v98, v212, v213
    v_cvt_pk_bf16_f32 v99, v214, v215
    v_pk_max_i16 v96, v96, 0
    v_pk_max_i16 v97, v97, 0
    v_pk_max_i16 v98, v98, 0
    v_pk_max_i16 v99, v99, 0
    buffer_store_dwordx4 v[96:99], v11, s[60:63], s86 offen offset:2048 sc1
    v_cvt_pk_bf16_f32 v100, v216, v217
    v_cvt_pk_bf16_f32 v101, v218, v219
    v_cvt_pk_bf16_f32 v102, v220, v221
    v_cvt_pk_bf16_f32 v103, v222, v223
    v_pk_max_i16 v100, v100, 0
    v_pk_max_i16 v101, v101, 0
    v_pk_max_i16 v102, v102, 0
    v_pk_max_i16 v103, v103, 0
    buffer_store_dwordx4 v[100:103], v11, s[60:63], s87 offen offset:2048 sc1
    s_barrier
    ds_read_b64_tr_b16 v[16:17], v12 offset:0
    ds_read_b64_tr_b16 v[18:19], v12 offset:2048
    ds_read_b64_tr_b16 v[20:21], v13 offset:0
    ds_read_b64_tr_b16 v[22:23], v13 offset:2048
    ds_read_b64_tr_b16 v[24:25], v14 offset:0
    ds_read_b64_tr_b16 v[26:27], v14 offset:2048
    ds_read_b64_tr_b16 v[28:29], v15 offset:0
    ds_read_b64_tr_b16 v[30:31], v15 offset:2048
    s_waitcnt lgkmcnt(0)
    v_mfma_f32_16x16x32_bf16 v[224:227], v[64:67], v[16:19], 0
    ds_read_b64_tr_b16 v[32:33], v12 offset:4096
    ds_read_b64_tr_b16 v[34:35], v12 offset:6144
    v_mfma_f32_16x16x32_bf16 v[228:231], v[64:67], v[20:23], 0
    ds_read_b64_tr_b16 v[36:37], v13 offset:4096
    ds_read_b64_tr_b16 v[38:39], v13 offset:6144
    v_mfma_f32_16x16x32_bf16 v[232:235], v[64:67], v[24:27], 0
    ds_read_b64_tr_b16 v[40:41], v14 offset:4096
    ds_read_b64_tr_b16 v[42:43], v14 offset:6144
    v_mfma_f32_16x16x32_bf16 v[236:239], v[64:67], v[28:31], 0
    ds_read_b64_tr_b16 v[44:45], v15 offset:4096
    ds_read_b64_tr_b16 v[46:47], v15 offset:6144
    v_mfma_f32_16x16x32_bf16 v[240:243], v[68:71], v[16:19], 0
    v_mfma_f32_16x16x32_bf16 v[244:247], v[68:71], v[20:23], 0
    v_mfma_f32_16x16x32_bf16 v[248:251], v[68:71], v[24:27], 0
    v_mfma_f32_16x16x32_bf16 v[252:255], v[68:71], v[28:31], 0
    s_waitcnt vmcnt(0)
    s_mov_b64 exec, 0x3ff
    buffer_store_dword v53, v52, s[68:71], 0 offen sc1
    s_mov_b64 exec, -1
    s_barrier
    s_waitcnt lgkmcnt(0)
    v_mfma_f32_16x16x32_bf16 v[224:227], v[72:75], v[32:35], v[224:227]
    ds_read_b64_tr_b16 v[16:17], v12 offset:8192
    ds_read_b64_tr_b16 v[18:19], v12 offset:10240
    v_mfma_f32_16x16x32_bf16 v[228:231], v[72:75], v[36:39], v[228:231]
    ds_read_b64_tr_b16 v[20:21], v13 offset:8192
    ds_read_b64_tr_b16 v[22:23], v13 offset:10240
    v_mfma_f32_16x16x32_bf16 v[232:235], v[72:75], v[40:43], v[232:235]
    ds_read_b64_tr_b16 v[24:25], v14 offset:8192
    ds_read_b64_tr_b16 v[26:27], v14 offset:10240
    v_mfma_f32_16x16x32_bf16 v[236:239], v[72:75], v[44:47], v[236:239]
    ds_read_b64_tr_b16 v[28:29], v15 offset:8192
    ds_read_b64_tr_b16 v[30:31], v15 offset:10240
    v_mfma_f32_16x16x32_bf16 v[240:243], v[76:79], v[32:35], v[240:243]
    v_mfma_f32_16x16x32_bf16 v[244:247], v[76:79], v[36:39], v[244:247]
    v_mfma_f32_16x16x32_bf16 v[248:251], v[76:79], v[40:43], v[248:251]
    v_mfma_f32_16x16x32_bf16 v[252:255], v[76:79], v[44:47], v[252:255]
    s_waitcnt lgkmcnt(0)
    v_mfma_f32_16x16x32_bf16 v[224:227], v[80:83], v[16:19], v[224:227]
    ds_read_b64_tr_b16 v[32:33], v12 offset:12288
    ds_read_b64_tr_b16 v[34:35], v12 offset:14336
    v_mfma_f32_16x16x32_bf16 v[228:231], v[80:83], v[20:23], v[228:231]
    ds_read_b64_tr_b16 v[36:37], v13 offset:12288
    ds_read_b64_tr_b16 v[38:39], v13 offset:14336
    v_mfma_f32_16x16x32_bf16 v[232:235], v[80:83], v[24:27], v[232:235]
    ds_read_b64_tr_b16 v[40:41], v14 offset:12288
    ds_read_b64_tr_b16 v[42:43], v14 offset:14336
    v_mfma_f32_16x16x32_bf16 v[236:239], v[80:83], v[28:31], v[236:239]
    ds_read_b64_tr_b16 v[44:45], v15 offset:12288
    ds_read_b64_tr_b16 v[46:47], v15 offset:14336
    v_mfma_f32_16x16x32_bf16 v[240:243], v[84:87], v[16:19], v[240:243]
    v_mfma_f32_16x16x32_bf16 v[244:247], v[84:87], v[20:23], v[244:247]
    v_mfma_f32_16x16x32_bf16 v[248:251], v[84:87], v[24:27], v[248:251]
    v_mfma_f32_16x16x32_bf16 v[252:255], v[84:87], v[28:31], v[252:255]
    s_waitcnt lgkmcnt(0)
    v_mfma_f32_16x16x32_bf16 v[224:227], v[88:91], v[32:35], v[224:227]
    ds_read_b64_tr_b16 v[16:17], v12 offset:16384
    ds_read_b64_tr_b16 v[18:19], v12 offset:18432
    v_mfma_f32_16x16x32_bf16 v[228:231], v[88:91], v[36:39], v[228:231]
    ds_read_b64_tr_b16 v[20:21], v13 offset:16384
    ds_read_b64_tr_b16 v[22:23], v13 offset:18432
    v_mfma_f32_16x16x32_bf16 v[232:235], v[88:91], v[40:43], v[232:235]
    ds_read_b64_tr_b16 v[24:25], v14 offset:16384
    ds_read_b64_tr_b16 v[26:27], v14 offset:18432
    v_mfma_f32_16x16x32_bf16 v[236:239], v[88:91], v[44:47], v[236:239]
    ds_read_b64_tr_b16 v[28:29], v15 offset:16384
    ds_read_b64_tr_b16 v[30:31], v15 offset:18432
    v_mfma_f32_16x16x32_bf16 v[240:243], v[92:95], v[32:35], v[240:243]
    v_mfma_f32_16x16x32_bf16 v[244:247], v[92:95], v[36:39], v[244:247]
    v_mfma_f32_16x16x32_bf16 v[248:251], v[92:95], v[40:43], v[248:251]
    v_mfma_f32_16x16x32_bf16 v[252:255], v[92:95], v[44:47], v[252:255]
    s_waitcnt lgkmcnt(0)
    v_mfma_f32_16x16x32_bf16 v[224:227], v[96:99], v[16:19], v[224:227]
    ds_read_b64_tr_b16 v[32:33], v12 offset:20480
    ds_read_b64_tr_b16 v[34:35], v12 offset:22528
    v_mfma_f32_16x16x32_bf16 v[228:231], v[96:99], v[20:23], v[228:231]
    ds_read_b64_tr_b16 v[36:37], v13 offset:20480
    ds_read_b64_tr_b16 v[38:39], v13 offset:22528
    v_mfma_f32_16x16x32_bf16 v[232:235], v[96:99], v[24:27], v[232:235]
    ds_read_b64_tr_b16 v[40:41], v14 offset:20480
    ds_read_b64_tr_b16 v[42:43], v14 offset:22528
    v_mfma_f32_16x16x32_bf16 v[236:239], v[96:99], v[28:31], v[236:239]
    ds_read_b64_tr_b16 v[44:45], v15 offset:20480
    ds_read_b64_tr_b16 v[46:47], v15 offset:22528
    v_mfma_f32_16x16x32_bf16 v[240:243], v[100:103], v[16:19], v[240:243]
    v_mfma_f32_16x16x32_bf16 v[244:247], v[100:103], v[20:23], v[244:247]
    v_mfma_f32_16x16x32_bf16 v[248:251], v[100:103], v[24:27], v[248:251]
    v_mfma_f32_16x16x32_bf16 v[252:255], v[100:103], v[28:31], v[252:255]
    s_mov_b32 s6, 0
    buffer_load_dword v58, v54, s[60:63], s6 offen
    s_mov_b32 s6, 49152
    buffer_load_dword v58, v54, s[60:63], s6 offen
    v_lshlrev_b32 v2, 4, v1
    s_and_b32 s12, s3, 3
    s_lshl_b32 s6, s12, 12
    s_add_u32 s7, s6, 94208
    s_add_u32 s6, s6, 73728
    v_add_u32 v3, s6, v2
    v_add_u32 v4, s7, v2
    s_lshl_b32 s6, s12, 10
    s_add_u32 s6, s6, 90112
    v_add_u32 v10, s6, v2
    v_and_b32 v5, 15, v1
    v_lshrrev_b32 v6, 4, v1
    v_lshrrev_b32 v7, 2, v5
    v_xor_b32 v7, v7, v6
    v_lshlrev_b32 v7, 3, v7
    v_lshl_add_u32 v7, v5, 5, v7
    v_add_u32 v7, s7, v7
    v_lshlrev_b32 v8, 1, v6
    v_xor_b32 v8, v8, v1
    v_and_b32 v8, 3, v8
    v_lshlrev_b32 v8, 3, v8
    v_bfe_u32 v9, v1, 2, 2
    v_lshl_add_u32 v9, v6, 3, v9
    v_lshl_add_u32 v8, v9, 5, v8
    v_add_u32 v8, s7, v8
    v_xor_b32 v9, 8, v8
    v_add_u32 v5, s16, v5
    s_movk_i32 s6, 1280
    v_mul_u32_u24 v5, s6, v5
    v_lshl_add_u32 v5, v6, 4, v5
    s_lshl_b32 s6, s11, 7
    v_add_u32 v5, s6, v5
HP_11:
    s_load_dwordx16 s[20:35], s[46:47], s36 glc
    s_waitcnt lgkmcnt(0)
    s_and_b64 s[6:7], s[20:21], s[22:23]
    s_and_b64 s[12:13], s[24:25], s[26:27]
    s_and_b64 s[6:7], s[6:7], s[28:29]
    s_and_b64 s[6:7], s[6:7], s[12:13]
    s_and_b32 s6, s6, s7
    s_cbranch_scc0 HP_11
HPD_12:
    buffer_load_dwordx4 v[104:107], v60, s[60:63], s17 offen sc1
    buffer_load_dwordx4 v[108:111], v61, s[60:63], s17 offen sc1
    s_add_u32 s17, s17, 2048
    s_cmp_ge_u32 s17, 49152
    s_cselect_b32 s6, 49152, 0
    s_sub_u32 s17, s17, s6
    buffer_load_dwordx4 v[112:115], v60, s[60:63], s17 offen sc1
    buffer_load_dwordx4 v[116:119], v61, s[60:63], s17 offen sc1
    s_add_u32 s17, s17, 7168
    s_cmp_ge_u32 s17, 49152
    s_cselect_b32 s6, 49152, 0
    s_sub_u32 s17, s17, s6
    buffer_load_dwordx4 v[120:123], v60, s[60:63], s17 offen sc1
    buffer_load_dwordx4 v[124:127], v61, s[60:63], s17 offen sc1
    s_add_u32 s17, s17, 2048
    s_cmp_ge_u32 s17, 49152
    s_cselect_b32 s6, 49152, 0
    s_sub_u32 s17, s17, s6
    buffer_load_dwordx4 v[128:131], v60, s[60:63], s17 offen sc1
    buffer_load_dwordx4 v[132:135], v61, s[60:63], s17 offen sc1
    s_add_u32 s17, s17, 2048
    s_cmp_ge_u32 s17, 49152
    s_cselect_b32 s6, 49152, 0
    s_sub_u32 s17, s17, s6
    buffer_load_dwordx4 v[136:139], v60, s[60:63], s17 offen sc1
    buffer_load_dwordx4 v[140:143], v61, s[60:63], s17 offen sc1
    s_add_u32 s17, s17, 7168
    s_cmp_ge_u32 s17, 49152
    s_cselect_b32 s6, 49152, 0
    s_sub_u32 s17, s17, s6
    s_barrier
    s_waitcnt vmcnt(8) lgkmcnt(0)
    v_mfma_f32_16x16x32_bf16 v[224:227], v[104:107], v[32:35], v[224:227]
    ds_read_b64_tr_b16 v[16:17], v12 offset:24576
    ds_read_b64_tr_b16 v[18:19], v12 offset:26624
    ds_read_b64_tr_b16 v[20:21], v13 offset:24576
    v_mfma_f32_16x16x32_bf16 v[228:231], v[104:107], v[36:39], v[228:231]
    ds_read_b64_tr_b16 v[22:23], v13 offset:26624
    ds_read_b64_tr_b16 v[24:25], v14 offset:24576
    ds_read_b64_tr_b16 v[26:27], v14 offset:26624
    v_mfma_f32_16x16x32_bf16 v[232:235], v[104:107], v[40:43], v[232:235]
    ds_read_b64_tr_b16 v[28:29], v15 offset:24576
    ds_read_b64_tr_b16 v[30:31], v15 offset:26624
    v_mfma_f32_16x16x32_bf16 v[236:239], v[104:107], v[44:47], v[236:239]
    buffer_load_dwordx4 v[144:147], v60, s[60:63], s17 offen sc1
    buffer_load_dwordx4 v[148:151], v61, s[60:63], s17 offen sc1
    s_add_u32 s17, s17, 2048
    s_cmp_ge_u32 s17, 49152
    s_cselect_b32 s6, 49152, 0
    s_sub_u32 s17, s17, s6
    v_mfma_f32_16x16x32_bf16 v[240:243], v[108:111], v[32:35], v[240:243]
    v_mfma_f32_16x16x32_bf16 v[244:247], v[108:111], v[36:39], v[244:247]
    v_mfma_f32_16x16x32_bf16 v[248:251], v[108:111], v[40:43], v[248:251]
    v_mfma_f32_16x16x32_bf16 v[252:255], v[108:111], v[44:47], v[252:255]
    s_waitcnt vmcnt(8) lgkmcnt(0)
    v_mfma_f32_16x16x32_bf16 v[224:227], v[112:115], v[16:19], v[224:227]
    ds_read_b64_tr_b16 v[32:33], v12 offset:28672
    ds_read_b64_tr_b16 v[34:35], v12 offset:30720
    ds_read_b64_tr_b16 v[36:37], v13 offset:28672
    v_mfma_f32_16x16x32_bf16 v[228:231], v[112:115], v[20:23], v[228:231]
    ds_read_b64_tr_b16 v[38:39], v13 offset:30720
    ds_read_b64_tr_b16 v[40:41], v14 offset:28672
    ds_read_b64_tr_b16 v[42:43], v14 offset:30720
    v_mfma_f32_16x16x32_bf16 v[232:235], v[112:115], v[24:27], v[232:235]
    ds_read_b64_tr_b16 v[44:45], v15 offset:28672
    ds_read_b64_tr_b16 v[46:47], v15 offset:30720
    v_mfma_f32_16x16x32_bf16 v[236:239], v[112:115], v[28:31], v[236:239]
    buffer_load_dwordx4 v[152:155], v60, s[60:63], s17 offen sc1
    buffer_load_dwordx4 v[156:159], v61, s[60:63], s17 offen sc1
    s_add_u32 s17, s17, 7168
    s_cmp_ge_u32 s17, 49152
    s_cselect_b32 s6, 49152, 0
    s_sub_u32 s17, s17, s6
    v_mfma_f32_16x16x32_bf16 v[240:243], v[116:119], v[16:19], v[240:243]
    v_mfma_f32_16x16x32_bf16 v[244:247], v[116:119], v[20:23], v[244:247]
    v_mfma_f32_16x16x32_bf16 v[248:251], v[116:119], v[24:27], v[248:251]
    v_mfma_f32_16x16x32_bf16 v[252:255], v[116:119], v[28:31], v[252:255]
    s_waitcnt vmcnt(8) lgkmcnt(0)
    v_mfma_f32_16x16x32_bf16 v[224:227], v[120:123], v[32:35], v[224:227]
    ds_read_b64_tr_b16 v[16:17], v12 offset:32768
    ds_read_b64_tr_b16 v[18:19], v12 offset:34816
    ds_read_b64_tr_b16 v[20:21], v13 offset:32768
    v_mfma_f32_16x16x32_bf16 v[228:231], v[120:123], v[36:39], v[228:231]
    ds_read_b64_tr_b16 v[22:23], v13 offset:34816
    ds_read_b64_tr_b16 v[24:25], v14 offset:32768
    ds_read_b64_tr_b16 v[26:27], v14 offset:34816
    v_mfma_f32_16x16x32_bf16 v[232:235], v[120:123], v[40:43], v[232:235]
    ds_read_b64_tr_b16 v[28:29], v15 offset:32768
    ds_read_b64_tr_b16 v[30:31], v15 offset:34816
    v_mfma_f32_16x16x32_bf16 v[236:239], v[120:123], v[44:47], v[236:239]
    buffer_load_dwordx4 v[160:163], v60, s[60:63], s17 offen sc1
    buffer_load_dwordx4 v[164:167], v61, s[60:63], s17 offen sc1
    s_add_u32 s17, s17, 1024
    s_cmp_ge_u32 s17, 49152
    s_cselect_b32 s6, 49152, 0
    s_sub_u32 s17, s17, s6
    v_mfma_f32_16x16x32_bf16 v[240:243], v[124:127], v[32:35], v[240:243]
    v_mfma_f32_16x16x32_bf16 v[244:247], v[124:127], v[36:39], v[244:247]
    v_mfma_f32_16x16x32_bf16 v[248:251], v[124:127], v[40:43], v[248:251]
    v_mfma_f32_16x16x32_bf16 v[252:255], v[124:127], v[44:47], v[252:255]
    s_waitcnt vmcnt(8) lgkmcnt(0)
    v_mfma_f32_16x16x32_bf16 v[224:227], v[128:131], v[16:19], v[224:227]
    ds_read_b64_tr_b16 v[32:33], v12 offset:36864
    ds_read_b64_tr_b16 v[34:35], v12 offset:38912
    ds_read_b64_tr_b16 v[36:37], v13 offset:36864
    v_mfma_f32_16x16x32_bf16 v[228:231], v[128:131], v[20:23], v[228:231]
    ds_read_b64_tr_b16 v[38:39], v13 offset:38912
    ds_read_b64_tr_b16 v[40:41], v14 offset:36864
    ds_read_b64_tr_b16 v[42:43], v14 offset:38912
    v_mfma_f32_16x16x32_bf16 v[232:235], v[128:131], v[24:27], v[232:235]
    ds_read_b64_tr_b16 v[44:45], v15 offset:36864
    ds_read_b64_tr_b16 v[46:47], v15 offset:38912
    v_mfma_f32_16x16x32_bf16 v[236:239], v[128:131], v[28:31], v[236:239]
    buffer_load_dwordx4 v[168:171], v60, s[60:63], s17 offen sc1
    buffer_load_dwordx4 v[172:175], v61, s[60:63], s17 offen sc1
    s_add_u32 s17, s17, 2048
    s_cmp_ge_u32 s17, 49152
    s_cselect_b32 s6, 49152, 0
    s_sub_u32 s17, s17, s6
    v_mfma_f32_16x16x32_bf16 v[240:243], v[132:135], v[16:19], v[240:243]
    v_mfma_f32_16x16x32_bf16 v[244:247], v[132:135], v[20:23], v[244:247]
    v_mfma_f32_16x16x32_bf16 v[248:251], v[132:135], v[24:27], v[248:251]
    v_mfma_f32_16x16x32_bf16 v[252:255], v[132:135], v[28:31], v[252:255]
    s_waitcnt vmcnt(8) lgkmcnt(0)
    v_mfma_f32_16x16x32_bf16 v[224:227], v[136:139], v[32:35], v[224:227]
    ds_read_b64_tr_b16 v[16:17], v12 offset:40960
    ds_read_b64_tr_b16 v[18:19], v12 offset:43008
    ds_read_b64_tr_b16 v[20:21], v13 offset:40960
    v_mfma_f32_16x16x32_bf16 v[228:231], v[136:139], v[36:39], v[228:231]
    ds_read_b64_tr_b16 v[22:23], v13 offset:43008
    ds_read_b64_tr_b16 v[24:25], v14 offset:40960
    ds_read_b64_tr_b16 v[26:27], v14 offset:43008
    v_mfma_f32_16x16x32_bf16 v[232:235], v[136:139], v[40:43], v[232:235]
    ds_read_b64_tr_b16 v[28:29], v15 offset:40960
    ds_read_b64_tr_b16 v[30:31], v15 offset:43008
    v_mfma_f32_16x16x32_bf16 v[236:239], v[136:139], v[44:47], v[236:239]
    buffer_load_dwordx4 v[176:179], v60, s[60:63], s17 offen sc1
    buffer_load_dwordx4 v[180:183], v61, s[60:63], s17 offen sc1
    s_add_u32 s17, s17, 1024
    s_cmp_ge_u32 s17, 49152
    s_cselect_b32 s6, 49152, 0
    s_sub_u32 s17, s17, s6
    v_mfma_f32_16x16x32_bf16 v[240:243], v[140:143], v[32:35], v[240:243]
    v_mfma_f32_16x16x32_bf16 v[244:247], v[140:143], v[36:39], v[244:247]
    v_mfma_f32_16x16x32_bf16 v[248:251], v[140:143], v[40:43], v[248:251]
    v_mfma_f32_16x16x32_bf16 v[252:255], v[140:143], v[44:47], v[252:255]
    s_waitcnt vmcnt(8) lgkmcnt(0)
    v_mfma_f32_16x16x32_bf16 v[224:227], v[144:147], v[16:19], v[224:227]
    ds_read_b64_tr_b16 v[32:33], v12 offset:45056
    ds_read_b64_tr_b16 v[34:35], v12 offset:47104
    ds_read_b64_tr_b16 v[36:37], v13 offset:45056
    v_mfma_f32_16x16x32_bf16 v[228:231], v[144:147], v[20:23], v[228:231]
    ds_read_b64_tr_b16 v[38:39], v13 offset:47104
    ds_read_b64_tr_b16 v[40:41], v14 offset:45056
    ds_read_b64_tr_b16 v[42:43], v14 offset:47104
    v_mfma_f32_16x16x32_bf16 v[232:235], v[144:147], v[24:27], v[232:235]
    ds_read_b64_tr_b16 v[44:45], v15 offset:45056
    ds_read_b64_tr_b16 v[46:47], v15 offset:47104
    v_mfma_f32_16x16x32_bf16 v[236:239], v[144:147], v[28:31], v[236:239]
    buffer_load_dwordx4 v[184:187], v60, s[60:63], s17 offen sc1
    buffer_load_dwordx4 v[188:191], v61, s[60:63], s17 offen sc1
    s_add_u32 s17, s17, 10240
    s_cmp_ge_u32 s17, 49152
    s_cselect_b32 s6, 49152, 0
    s_sub_u32 s17, s17, s6
    v_mfma_f32_16x16x32_bf16 v[240:243], v[148:151], v[16:19], v[240:243]
    v_mfma_f32_16x16x32_bf16 v[244:247], v[148:151], v[20:23], v[244:247]
    v_mfma_f32_16x16x32_bf16 v[248:251], v[148:151], v[24:27], v[248:251]
    v_mfma_f32_16x16x32_bf16 v[252:255], v[148:151], v[28:31], v[252:255]
    s_waitcnt vmcnt(8) lgkmcnt(0)
    v_mfma_f32_16x16x32_bf16 v[224:227], v[152:155], v[32:35], v[224:227]
    ds_read_b64_tr_b16 v[16:17], v12 offset:49152
    ds_read_b64_tr_b16 v[18:19], v12 offset:51200
    ds_read_b64_tr_b16 v[20:21], v13 offset:49152
    v_mfma_f32_16x16x32_bf16 v[228:231], v[152:155], v[36:39], v[228:231]
    ds_read_b64_tr_b16 v[22:23], v13 offset:51200
    ds_read_b64_tr_b16 v[24:25], v14 offset:49152
    ds_read_b64_tr_b16 v[26:27], v14 offset:51200
    v_mfma_f32_16x16x32_bf16 v[232:235], v[152:155], v[40:43], v[232:235]
    ds_read_b64_tr_b16 v[28:29], v15 offset:49152
    ds_read_b64_tr_b16 v[30:31], v15 offset:51200
    v_mfma_f32_16x16x32_bf16 v[236:239], v[152:155], v[44:47], v[236:239]
    buffer_load_dwordx4 v[192:195], v60, s[60:63], s17 offen sc1
    buffer_load_dwordx4 v[196:199], v61, s[60:63], s17 offen sc1
    s_add_u32 s17, s17, 1024
    s_cmp_ge_u32 s17, 49152
    s_cselect_b32 s6, 49152, 0
    s_sub_u32 s17, s17, s6
    v_mfma_f32_16x16x32_bf16 v[240:243], v[156:159], v[32:35], v[240:243]
    v_mfma_f32_16x16x32_bf16 v[244:247], v[156:159], v[36:39], v[244:247]
    v_mfma_f32_16x16x32_bf16 v[248:251], v[156:159], v[40:43], v[248:251]
    v_mfma_f32_16x16x32_bf16 v[252:255], v[156:159], v[44:47], v[252:255]
    s_waitcnt vmcnt(8) lgkmcnt(0)
    v_mfma_f32_16x16x32_bf16 v[224:227], v[160:163], v[16:19], v[224:227]
    v_add_u32 v12, 0xffff1000, v12
    v_add_u32 v13, 0xffff1000, v13
    v_add_u32 v14, 0xffff1000, v14
    v_mfma_f32_16x16x32_bf16 v[228:231], v[160:163], v[20:23], v[228:231]
    v_add_u32 v15, 0xffff1000, v15
    ds_read_b64_tr_b16 v[32:33], v12 offset:0
    ds_read_b64_tr_b16 v[34:35], v12 offset:2048
    v_mfma_f32_16x16x32_bf16 v[232:235], v[160:163], v[24:27], v[232:235]
    ds_read_b64_tr_b16 v[36:37], v13 offset:0
    ds_read_b64_tr_b16 v[38:39], v13 offset:2048
    ds_read_b64_tr_b16 v[40:41], v14 offset:0
    v_mfma_f32_16x16x32_bf16 v[236:239], v[160:163], v[28:31], v[236:239]
    buffer_load_dwordx4 v[200:203], v60, s[60:63], s17 offen sc1
    buffer_load_dwordx4 v[204:207], v61, s[60:63], s17 offen sc1
    s_add_u32 s17, s17, 2048
    s_cmp_ge_u32 s17, 49152
    s_cselect_b32 s6, 49152, 0
    s_sub_u32 s17, s17, s6
    ds_read_b64_tr_b16 v[42:43], v14 offset:2048
    ds_read_b64_tr_b16 v[44:45], v15 offset:0
    ds_read_b64_tr_b16 v[46:47], v15 offset:2048
    v_mfma_f32_16x16x32_bf16 v[240:243], v[164:167], v[16:19], v[240:243]
    v_mfma_f32_16x16x32_bf16 v[244:247], v[164:167], v[20:23], v[244:247]
    v_mfma_f32_16x16x32_bf16 v[248:251], v[164:167], v[24:27], v[248:251]
    v_mfma_f32_16x16x32_bf16 v[252:255], v[164:167], v[28:31], v[252:255]
    s_waitcnt vmcnt(8) lgkmcnt(0)
    v_mfma_f32_16x16x32_bf16 v[224:227], v[168:171], v[32:35], v[224:227]
    ds_read_b64_tr_b16 v[16:17], v12 offset:8192
    ds_read_b64_tr_b16 v[18:19], v12 offset:10240
    ds_read_b64_tr_b16 v[20:21], v13 offset:8192
    v_mfma_f32_16x16x32_bf16 v[228:231], v[168:171], v[36:39], v[228:231]
    ds_read_b64_tr_b16 v[22:23], v13 offset:10240
    ds_read_b64_tr_b16 v[24:25], v14 offset:8192
    ds_read_b64_tr_b16 v[26:27], v14 offset:10240
    v_mfma_f32_16x16x32_bf16 v[232:235], v[168:171], v[40:43], v[232:235]
    ds_read_b64_tr_b16 v[28:29], v15 offset:8192
    ds_read_b64_tr_b16 v[30:31], v15 offset:10240
    v_mfma_f32_16x16x32_bf16 v[236:239], v[168:171], v[44:47], v[236:239]
    buffer_load_dwordx4 v[208:211], v60, s[60:63], s17 offen sc1
    buffer_load_dwordx4 v[212:215], v61, s[60:63], s17 offen sc1
    s_add_u32 s17, s17, 6144
    s_cmp_ge_u32 s17, 49152
    s_cselect_b32 s6, 49152, 0
    s_sub_u32 s17, s17, s6
    v_mfma_f32_16x16x32_bf16 v[240:243], v[172:175], v[32:35], v[240:243]
    v_mfma_f32_16x16x32_bf16 v[244:247], v[172:175], v[36:39], v[244:247]
    v_mfma_f32_16x16x32_bf16 v[248:251], v[172:175], v[40:43], v[248:251]
    v_mfma_f32_16x16x32_bf16 v[252:255], v[172:175], v[44:47], v[252:255]
    s_waitcnt vmcnt(8) lgkmcnt(0)
    v_mfma_f32_16x16x32_bf16 v[224:227], v[176:179], v[16:19], v[224:227]
    ds_read_b64_tr_b16 v[32:33], v12 offset:12288
    ds_read_b64_tr_b16 v[34:35], v12 offset:14336
    ds_read_b64_tr_b16 v[36:37], v13 offset:12288
    v_mfma_f32_16x16x32_bf16 v[228:231], v[176:179], v[20:23], v[228:231]
    ds_read_b64_tr_b16 v[38:39], v13 offset:14336
    ds_read_b64_tr_b16 v[40:41], v14 offset:12288
    ds_read_b64_tr_b16 v[42:43], v14 offset:14336
    v_mfma_f32_16x16x32_bf16 v[232:235], v[176:179], v[24:27], v[232:235]
    ds_read_b64_tr_b16 v[44:45], v15 offset:12288
    ds_read_b64_tr_b16 v[46:47], v15 offset:14336
    v_mfma_f32_16x16x32_bf16 v[236:239], v[176:179], v[28:31], v[236:239]
    buffer_load_dwordx4 v[216:219], v60, s[60:63], s17 offen sc1
    buffer_load_dwordx4 v[220:223], v61, s[60:63], s17 offen sc1
    s_add_u32 s17, s17, 2048
    s_cmp_ge_u32 s17, 49152
    s_cselect_b32 s6, 49152, 0
    s_sub_u32 s17, s17, s6
    v_mfma_f32_16x16x32_bf16 v[240:243], v[180:183], v[16:19], v[240:243]
    v_mfma_f32_16x16x32_bf16 v[244:247], v[180:183], v[20:23], v[244:247]
    v_mfma_f32_16x16x32_bf16 v[248:251], v[180:183], v[24:27], v[248:251]
    v_mfma_f32_16x16x32_bf16 v[252:255], v[180:183], v[28:31], v[252:255]
    s_waitcnt vmcnt(8) lgkmcnt(0)
    v_mfma_f32_16x16x32_bf16 v[224:227], v[184:187], v[32:35], v[224:227]
    ds_read_b64_tr_b16 v[16:17], v12 offset:16384
    ds_read_b64_tr_b16 v[18:19], v12 offset:18432
    ds_read_b64_tr_b16 v[20:21], v13 offset:16384
    v_mfma_f32_16x16x32_bf16 v[228:231], v[184:187], v[36:39], v[228:231]
    ds_read_b64_tr_b16 v[22:23], v13 offset:18432
    ds_read_b64_tr_b16 v[24:25], v14 offset:16384
    ds_read_b64_tr_b16 v[26:27], v14 offset:18432
    v_mfma_f32_16x16x32_bf16 v[232:235], v[184:187], v[40:43], v[232:235]
    ds_read_b64_tr_b16 v[28:29], v15 offset:16384
    ds_read_b64_tr_b16 v[30:31], v15 offset:18432
    v_mfma_f32_16x16x32_bf16 v[236:239], v[184:187], v[44:47], v[236:239]
    buffer_load_dwordx4 v[104:107], v60, s[60:63], s17 offen sc1
    buffer_load_dwordx4 v[108:111], v61, s[60:63], s17 offen sc1
    s_add_u32 s17, s17, 1024
    s_cmp_ge_u32 s17, 49152
    s_cselect_b32 s6, 49152, 0
    s_sub_u32 s17, s17, s6
    v_mfma_f32_16x16x32_bf16 v[240:243], v[188:191], v[32:35], v[240:243]
    v_mfma_f32_16x16x32_bf16 v[244:247], v[188:191], v[36:39], v[244:247]
    v_mfma_f32_16x16x32_bf16 v[248:251], v[188:191], v[40:43], v[248:251]
    v_mfma_f32_16x16x32_bf16 v[252:255], v[188:191], v[44:47], v[252:255]
    s_waitcnt vmcnt(8) lgkmcnt(0)
    v_mfma_f32_16x16x32_bf16 v[224:227], v[192:195], v[16:19], v[224:227]
    ds_read_b64_tr_b16 v[32:33], v12 offset:20480
    ds_read_b64_tr_b16 v[34:35], v12 offset:22528
    ds_read_b64_tr_b16 v[36:37], v13 offset:20480
    v_mfma_f32_16x16x32_bf16 v[228:231], v[192:195], v[20:23], v[228:231]
    ds_read_b64_tr_b16 v[38:39], v13 offset:22528
    ds_read_b64_tr_b16 v[40:41], v14 offset:20480
    ds_read_b64_tr_b16 v[42:43], v14 offset:22528
    v_mfma_f32_16x16x32_bf16 v[232:235], v[192:195], v[24:27], v[232:235]
    ds_read_b64_tr_b16 v[44:45], v15 offset:20480
    ds_read_b64_tr_b16 v[46:47], v15 offset:22528
    v_mfma_f32_16x16x32_bf16 v[236:239], v[192:195], v[28:31], v[236:239]
    buffer_load_dwordx4 v[112:115], v60, s[60:63], s17 offen sc1
    buffer_load_dwordx4 v[116:119], v61, s[60:63], s17 offen sc1
    s_add_u32 s17, s17, 7168
    s_cmp_ge_u32 s17, 49152
    s_cselect_b32 s6, 49152, 0
    s_sub_u32 s17, s17, s6
    v_mfma_f32_16x16x32_bf16 v[240:243], v[196:199], v[16:19], v[240:243]
    v_mfma_f32_16x16x32_bf16 v[244:247], v[196:199], v[20:23], v[244:247]
    v_mfma_f32_16x16x32_bf16 v[248:251], v[196:199], v[24:27], v[248:251]
    v_mfma_f32_16x16x32_bf16 v[252:255], v[196:199], v[28:31], v[252:255]
    s_waitcnt vmcnt(8) lgkmcnt(0)
    v_mfma_f32_16x16x32_bf16 v[224:227], v[200:203], v[32:35], v[224:227]
    ds_read_b64_tr_b16 v[16:17], v12 offset:24576
    ds_read_b64_tr_b16 v[18:19], v12 offset:26624
    ds_read_b64_tr_b16 v[20:21], v13 offset:24576
    v_mfma_f32_16x16x32_bf16 v[228:231], v[200:203], v[36:39], v[228:231]
    ds_read_b64_tr_b16 v[22:23], v13 offset:26624
    ds_read_b64_tr_b16 v[24:25], v14 offset:24576
    ds_read_b64_tr_b16 v[26:27], v14 offset:26624
    v_mfma_f32_16x16x32_bf16 v[232:235], v[200:203], v[40:43], v[232:235]
    ds_read_b64_tr_b16 v[28:29], v15 offset:24576
    ds_read_b64_tr_b16 v[30:31], v15 offset:26624
    v_mfma_f32_16x16x32_bf16 v[236:239], v[200:203], v[44:47], v[236:239]
    buffer_load_dwordx4 v[120:123], v60, s[60:63], s17 offen sc1
    buffer_load_dwordx4 v[124:127], v61, s[60:63], s17 offen sc1
    s_add_u32 s17, s17, 1024
    s_cmp_ge_u32 s17, 49152
    s_cselect_b32 s6, 49152, 0
    s_sub_u32 s17, s17, s6
    v_mfma_f32_16x16x32_bf16 v[240:243], v[204:207], v[32:35], v[240:243]
    v_mfma_f32_16x16x32_bf16 v[244:247], v[204:207], v[36:39], v[244:247]
    v_mfma_f32_16x16x32_bf16 v[248:251], v[204:207], v[40:43], v[248:251]
    v_mfma_f32_16x16x32_bf16 v[252:255], v[204:207], v[44:47], v[252:255]
    s_waitcnt vmcnt(8) lgkmcnt(0)
    v_mfma_f32_16x16x32_bf16 v[224:227], v[208:211], v[16:19], v[224:227]
    ds_read_b64_tr_b16 v[32:33], v12 offset:28672
    ds_read_b64_tr_b16 v[34:35], v12 offset:30720
    ds_read_b64_tr_b16 v[36:37], v13 offset:28672
    v_mfma_f32_16x16x32_bf16 v[228:231], v[208:211], v[20:23], v[228:231]
    ds_read_b64_tr_b16 v[38:39], v13 offset:30720
    ds_read_b64_tr_b16 v[40:41], v14 offset:28672
    ds_read_b64_tr_b16 v[42:43], v14 offset:30720
    v_mfma_f32_16x16x32_bf16 v[232:235], v[208:211], v[24:27], v[232:235]
    ds_read_b64_tr_b16 v[44:45], v15 offset:28672
    ds_read_b64_tr_b16 v[46:47], v15 offset:30720
    v_mfma_f32_16x16x32_bf16 v[236:239], v[208:211], v[28:31], v[236:239]
    buffer_load_dwordx4 v[128:131], v60, s[60:63], s17 offen sc1
    buffer_load_dwordx4 v[132:135], v61, s[60:63], s17 offen sc1
    s_add_u32 s17, s17, 2048
    s_cmp_ge_u32 s17, 49152
    s_cselect_b32 s6, 49152, 0
    s_sub_u32 s17, s17, s6
    v_mfma_f32_16x16x32_bf16 v[240:243], v[212:215], v[16:19], v[240:243]
    v_mfma_f32_16x16x32_bf16 v[244:247], v[212:215], v[20:23], v[244:247]
    v_mfma_f32_16x16x32_bf16 v[248:251], v[212:215], v[24:27], v[248:251]
    v_mfma_f32_16x16x32_bf16 v[252:255], v[212:215], v[28:31], v[252:255]
    s_waitcnt vmcnt(8) lgkmcnt(0)
    v_mfma_f32_16x16x32_bf16 v[224:227], v[216:219], v[32:35], v[224:227]
    ds_read_b64_tr_b16 v[16:17], v12 offset:32768
    ds_read_b64_tr_b16 v[18:19], v12 offset:34816
    ds_read_b64_tr_b16 v[20:21], v13 offset:32768
    v_mfma_f32_16x16x32_bf16 v[228:231], v[216:219], v[36:39], v[228:231]
    ds_read_b64_tr_b16 v[22:23], v13 offset:34816
    ds_read_b64_tr_b16 v[24:25], v14 offset:32768
    ds_read_b64_tr_b16 v[26:27], v14 offset:34816
    v_mfma_f32_16x16x32_bf16 v[232:235], v[216:219], v[40:43], v[232:235]
    ds_read_b64_tr_b16 v[28:29], v15 offset:32768
    ds_read_b64_tr_b16 v[30:31], v15 offset:34816
    v_mfma_f32_16x16x32_bf16 v[236:239], v[216:219], v[44:47], v[236:239]
    buffer_load_dwordx4 v[136:139], v60, s[60:63], s17 offen sc1
    buffer_load_dwordx4 v[140:143], v61, s[60:63], s17 offen sc1
    s_add_u32 s17, s17, 1024
    s_cmp_ge_u32 s17, 49152
    s_cselect_b32 s6, 49152, 0
    s_sub_u32 s17, s17, s6
    v_mfma_f32_16x16x32_bf16 v[240:243], v[220:223], v[32:35], v[240:243]
    v_mfma_f32_16x16x32_bf16 v[244:247], v[220:223], v[36:39], v[244:247]
    v_mfma_f32_16x16x32_bf16 v[248:251], v[220:223], v[40:43], v[248:251]
    v_mfma_f32_16x16x32_bf16 v[252:255], v[220:223], v[44:47], v[252:255]
    s_waitcnt vmcnt(8) lgkmcnt(0)
    v_mfma_f32_16x16x32_bf16 v[224:227], v[104:107], v[16:19], v[224:227]
    ds_read_b64_tr_b16 v[32:33], v12 offset:36864
    ds_read_b64_tr_b16 v[34:35], v12 offset:38912
    ds_read_b64_tr_b16 v[36:37], v13 offset:36864
    v_mfma_f32_16x16x32_bf16 v[228:231], v[104:107], v[20:23], v[228:231]
    ds_read_b64_tr_b16 v[38:39], v13 offset:38912
    ds_read_b64_tr_b16 v[40:41], v14 offset:36864
    ds_read_b64_tr_b16 v[42:43], v14 offset:38912
    v_mfma_f32_16x16x32_bf16 v[232:235], v[104:107], v[24:27], v[232:235]
    ds_read_b64_tr_b16 v[44:45], v15 offset:36864
    ds_read_b64_tr_b16 v[46:47], v15 offset:38912
    v_mfma_f32_16x16x32_bf16 v[236:239], v[104:107], v[28:31], v[236:239]
    buffer_load_dwordx4 v[144:147], v60, s[60:63], s17 offen sc1
    buffer_load_dwordx4 v[148:151], v61, s[60:63], s17 offen sc1
    s_add_u32 s17, s17, 7168
    s_cmp_ge_u32 s17, 49152
    s_cselect_b32 s6, 49152, 0
    s_sub_u32 s17, s17, s6
    v_mfma_f32_16x16x32_bf16 v[240:243], v[108:111], v[16:19], v[240:243]
    v_mfma_f32_16x16x32_bf16 v[244:247], v[108:111], v[20:23], v[244:247]
    v_mfma_f32_16x16x32_bf16 v[248:251], v[108:111], v[24:27], v[248:251]
    v_mfma_f32_16x16x32_bf16 v[252:255], v[108:111], v[28:31], v[252:255]
    s_waitcnt vmcnt(8) lgkmcnt(0)
    v_mfma_f32_16x16x32_bf16 v[224:227], v[112:115], v[32:35], v[224:227]
    ds_read_b64_tr_b16 v[16:17], v12 offset:40960
    ds_read_b64_tr_b16 v[18:19], v12 offset:43008
    ds_read_b64_tr_b16 v[20:21], v13 offset:40960
    v_mfma_f32_16x16x32_bf16 v[228:231], v[112:115], v[36:39], v[228:231]
    ds_read_b64_tr_b16 v[22:23], v13 offset:43008
    ds_read_b64_tr_b16 v[24:25], v14 offset:40960
    ds_read_b64_tr_b16 v[26:27], v14 offset:43008
    v_mfma_f32_16x16x32_bf16 v[232:235], v[112:115], v[40:43], v[232:235]
    ds_read_b64_tr_b16 v[28:29], v15 offset:40960
    ds_read_b64_tr_b16 v[30:31], v15 offset:43008
    v_mfma_f32_16x16x32_bf16 v[236:239], v[112:115], v[44:47], v[236:239]
    buffer_load_dwordx4 v[152:155], v60, s[60:63], s17 offen sc1
    buffer_load_dwordx4 v[156:159], v61, s[60:63], s17 offen sc1
    s_add_u32 s17, s17, 1024
    s_cmp_ge_u32 s17, 49152
    s_cselect_b32 s6, 49152, 0
    s_sub_u32 s17, s17, s6
    v_mfma_f32_16x16x32_bf16 v[240:243], v[116:119], v[32:35], v[240:243]
    v_mfma_f32_16x16x32_bf16 v[244:247], v[116:119], v[36:39], v[244:247]
    v_mfma_f32_16x16x32_bf16 v[248:251], v[116:119], v[40:43], v[248:251]
    v_mfma_f32_16x16x32_bf16 v[252:255], v[116:119], v[44:47], v[252:255]
    s_waitcnt vmcnt(8) lgkmcnt(0)
    v_mfma_f32_16x16x32_bf16 v[224:227], v[120:123], v[16:19], v[224:227]
    ds_read_b64_tr_b16 v[32:33], v12 offset:45056
    ds_read_b64_tr_b16 v[34:35], v12 offset:47104
    ds_read_b64_tr_b16 v[36:37], v13 offset:45056
    v_mfma_f32_16x16x32_bf16 v[228:231], v[120:123], v[20:23], v[228:231]
    ds_read_b64_tr_b16 v[38:39], v13 offset:47104
    ds_read_b64_tr_b16 v[40:41], v14 offset:45056
    ds_read_b64_tr_b16 v[42:43], v14 offset:47104
    v_mfma_f32_16x16x32_bf16 v[232:235], v[120:123], v[24:27], v[232:235]
    ds_read_b64_tr_b16 v[44:45], v15 offset:45056
    ds_read_b64_tr_b16 v[46:47], v15 offset:47104
    v_mfma_f32_16x16x32_bf16 v[236:239], v[120:123], v[28:31], v[236:239]
    buffer_load_dwordx4 v[160:163], v60, s[60:63], s17 offen sc1
    buffer_load_dwordx4 v[164:167], v61, s[60:63], s17 offen sc1
    s_add_u32 s17, s17, 2048
    s_cmp_ge_u32 s17, 49152
    s_cselect_b32 s6, 49152, 0
    s_sub_u32 s17, s17, s6
    v_mfma_f32_16x16x32_bf16 v[240:243], v[124:127], v[16:19], v[240:243]
    v_mfma_f32_16x16x32_bf16 v[244:247], v[124:127], v[20:23], v[244:247]
    v_mfma_f32_16x16x32_bf16 v[248:251], v[124:127], v[24:27], v[248:251]
    v_mfma_f32_16x16x32_bf16 v[252:255], v[124:127], v[28:31], v[252:255]
    s_waitcnt vmcnt(8) lgkmcnt(0)
    v_mfma_f32_16x16x32_bf16 v[224:227], v[128:131], v[32:35], v[224:227]
    ds_read_b64_tr_b16 v[16:17], v12 offset:49152
    ds_read_b64_tr_b16 v[18:19], v12 offset:51200
    ds_read_b64_tr_b16 v[20:21], v13 offset:49152
    v_mfma_f32_16x16x32_bf16 v[228:231], v[128:131], v[36:39], v[228:231]
    ds_read_b64_tr_b16 v[22:23], v13 offset:51200
    ds_read_b64_tr_b16 v[24:25], v14 offset:49152
    ds_read_b64_tr_b16 v[26:27], v14 offset:51200
    v_mfma_f32_16x16x32_bf16 v[232:235], v[128:131], v[40:43], v[232:235]
    ds_read_b64_tr_b16 v[28:29], v15 offset:49152
    ds_read_b64_tr_b16 v[30:31], v15 offset:51200
    v_mfma_f32_16x16x32_bf16 v[236:239], v[128:131], v[44:47], v[236:239]
    buffer_load_dwordx4 v[168:171], v60, s[60:63], s17 offen sc1
    buffer_load_dwordx4 v[172:175], v61, s[60:63], s17 offen sc1
    s_add_u32 s17, s17, 6144
    s_cmp_ge_u32 s17, 49152
    s_cselect_b32 s6, 49152, 0
    s_sub_u32 s17, s17, s6
    v_mfma_f32_16x16x32_bf16 v[240:243], v[132:135], v[32:35], v[240:243]
    v_mfma_f32_16x16x32_bf16 v[244:247], v[132:135], v[36:39], v[244:247]
    v_mfma_f32_16x16x32_bf16 v[248:251], v[132:135], v[40:43], v[248:251]
    v_mfma_f32_16x16x32_bf16 v[252:255], v[132:135], v[44:47], v[252:255]
    s_waitcnt vmcnt(8) lgkmcnt(0)
    v_mfma_f32_16x16x32_bf16 v[224:227], v[136:139], v[16:19], v[224:227]
    ds_read_b64_tr_b16 v[32:33], v12 offset:53248
    ds_read_b64_tr_b16 v[34:35], v12 offset:55296
    ds_read_b64_tr_b16 v[36:37], v13 offset:53248
    v_mfma_f32_16x16x32_bf16 v[228:231], v[136:139], v[20:23], v[228:231]
    ds_read_b64_tr_b16 v[38:39], v13 offset:55296
    ds_read_b64_tr_b16 v[40:41], v14 offset:53248
    ds_read_b64_tr_b16 v[42:43], v14 offset:55296
    v_mfma_f32_16x16x32_bf16 v[232:235], v[136:139], v[24:27], v[232:235]
    ds_read_b64_tr_b16 v[44:45], v15 offset:53248
    ds_read_b64_tr_b16 v[46:47], v15 offset:55296
    v_mfma_f32_16x16x32_bf16 v[236:239], v[136:139], v[28:31], v[236:239]
    buffer_load_dwordx4 v[176:179], v60, s[60:63], s17 offen sc1
    buffer_load_dwordx4 v[180:183], v61, s[60:63], s17 offen sc1
    s_add_u32 s17, s17, 2048
    s_cmp_ge_u32 s17, 49152
    s_cselect_b32 s6, 49152, 0
    s_sub_u32 s17, s17, s6
    v_mfma_f32_16x16x32_bf16 v[240:243], v[140:143], v[16:19], v[240:243]
    v_mfma_f32_16x16x32_bf16 v[244:247], v[140:143], v[20:23], v[244:247]
    v_mfma_f32_16x16x32_bf16 v[248:251], v[140:143], v[24:27], v[248:251]
    v_mfma_f32_16x16x32_bf16 v[252:255], v[140:143], v[28:31], v[252:255]
    s_waitcnt vmcnt(8) lgkmcnt(0)
    v_mfma_f32_16x16x32_bf16 v[224:227], v[144:147], v[32:35], v[224:227]
    ds_read_b64_tr_b16 v[16:17], v12 offset:57344
    ds_read_b64_tr_b16 v[18:19], v12 offset:59392
    ds_read_b64_tr_b16 v[20:21], v13 offset:57344
    v_mfma_f32_16x16x32_bf16 v[228:231], v[144:147], v[36:39], v[228:231]
    ds_read_b64_tr_b16 v[22:23], v13 offset:59392
    ds_read_b64_tr_b16 v[24:25], v14 offset:57344
    ds_read_b64_tr_b16 v[26:27], v14 offset:59392
    v_mfma_f32_16x16x32_bf16 v[232:235], v[144:147], v[40:43], v[232:235]
    ds_read_b64_tr_b16 v[28:29], v15 offset:57344
    ds_read_b64_tr_b16 v[30:31], v15 offset:59392
    v_mfma_f32_16x16x32_bf16 v[236:239], v[144:147], v[44:47], v[236:239]
    buffer_load_dwordx4 v[184:187], v60, s[60:63], s17 offen sc1
    buffer_load_dwordx4 v[188:191], v61, s[60:63], s17 offen sc1
    v_mfma_f32_16x16x32_bf16 v[240:243], v[148:151], v[32:35], v[240:243]
    v_mfma_f32_16x16x32_bf16 v[244:247], v[148:151], v[36:39], v[244:247]
    v_mfma_f32_16x16x32_bf16 v[248:251], v[148:151], v[40:43], v[248:251]
    v_mfma_f32_16x16x32_bf16 v[252:255], v[148:151], v[44:47], v[252:255]
    s_waitcnt vmcnt(8) lgkmcnt(0)
    v_mfma_f32_16x16x32_bf16 v[224:227], v[152:155], v[16:19], v[224:227]
    v_add_u32 v12, 0x21000, v12
    v_add_u32 v13, 0x21000, v13
    v_add_u32 v14, 0x21000, v14
    v_mfma_f32_16x16x32_bf16 v[228:231], v[152:155], v[20:23], v[228:231]
    v_add_u32 v15, 0x21000, v15
    ds_read_b64_tr_b16 v[32:33], v12 offset:0
    ds_read_b64_tr_b16 v[34:35], v12 offset:2048
    v_mfma_f32_16x16x32_bf16 v[232:235], v[152:155], v[24:27], v[232:235]
    ds_read_b64_tr_b16 v[36:37], v13 offset:0
    ds_read_b64_tr_b16 v[38:39], v13 offset:2048
    ds_read_b64_tr_b16 v[40:41], v14 offset:0
    v_mfma_f32_16x16x32_bf16 v[236:239], v[152:155], v[28:31], v[236:239]
    ds_read_b64_tr_b16 v[42:43], v14 offset:2048
    ds_read_b64_tr_b16 v[44:45], v15 offset:0
    ds_read_b64_tr_b16 v[46:47], v15 offset:2048
    v_mfma_f32_16x16x32_bf16 v[240:243], v[156:159], v[16:19], v[240:243]
    s_load_dwordx8 s[20:27], s[46:47], s37
    s_load_dword s28, s[46:47], s38
    v_mfma_f32_16x16x32_bf16 v[244:247], v[156:159], v[20:23], v[244:247]
    v_mfma_f32_16x16x32_bf16 v[248:251], v[156:159], v[24:27], v[248:251]
    v_mfma_f32_16x16x32_bf16 v[252:255], v[156:159], v[28:31], v[252:255]
    s_waitcnt vmcnt(6) lgkmcnt(0)
    s_and_b64 s[20:21], s[20:21], s[22:23]
    s_and_b64 s[24:25], s[24:25], s[26:27]
    s_and_b32 s20, s20, s28
    s_and_b64 s[20:21], s[20:21], s[24:25]
    s_and_b32 s20, s20, s21
    s_cselect_b32 s18, 1, 0
    s_cselect_b64 exec, -1, 0
    s_mov_b32 s6, 0
    buffer_load_dwordx2 v[48:49], v55, s[64:67], s6 offen sc1
    s_mov_b32 s6, 65536
    buffer_load_dwordx2 v[50:51], v55, s[64:67], s6 offen sc1
    s_mov_b32 s6, 131072
    buffer_load_dwordx2 v[52:53], v55, s[64:67], s6 offen sc1
    s_mov_b32 s6, 196608
    buffer_load_dwordx2 v[54:55], v55, s[64:67], s6 offen sc1
    buffer_load_dwordx4 v[56:59], v56, s[68:71], 0 offen sc1
    s_mov_b64 exec, -1
    v_mfma_f32_16x16x32_bf16 v[224:227], v[160:163], v[32:35], v[224:227]
    ds_read_b64_tr_b16 v[16:17], v12 offset:4096
    ds_read_b64_tr_b16 v[18:19], v12 offset:6144
    ds_read_b64_tr_b16 v[20:21], v13 offset:4096
    v_mfma_f32_16x16x32_bf16 v[228:231], v[160:163], v[36:39], v[228:231]
    ds_read_b64_tr_b16 v[22:23], v13 offset:6144
    ds_read_b64_tr_b16 v[24:25], v14 offset:4096
    ds_read_b64_tr_b16 v[26:27], v14 offset:6144
    v_mfma_f32_16x16x32_bf16 v[232:235], v[160:163], v[40:43], v[232:235]
    ds_read_b64_tr_b16 v[28:29], v15 offset:4096
    ds_read_b64_tr_b16 v[30:31], v15 offset:6144
    v_mfma_f32_16x16x32_bf16 v[236:239], v[160:163], v[44:47], v[236:239]
    v_mfma_f32_16x16x32_bf16 v[240:243], v[164:167], v[32:35], v[240:243]
    v_mfma_f32_16x16x32_bf16 v[244:247], v[164:167], v[36:39], v[244:247]
    v_mfma_f32_16x16x32_bf16 v[248:251], v[164:167], v[40:43], v[248:251]
    v_mfma_f32_16x16x32_bf16 v[252:255], v[164:167], v[44:47], v[252:255]
    s_waitcnt vmcnt(9) lgkmcnt(0)
    v_mfma_f32_16x16x32_bf16 v[224:227], v[168:171], v[16:19], v[224:227]
    ds_read_b64_tr_b16 v[32:33], v12 offset:8192
    ds_read_b64_tr_b16 v[34:35], v12 offset:10240
    ds_read_b64_tr_b16 v[36:37], v13 offset:8192
    v_mfma_f32_16x16x32_bf16 v[228:231], v[168:171], v[20:23], v[228:231]
    ds_read_b64_tr_b16 v[38:39], v13 offset:10240
    ds_read_b64_tr_b16 v[40:41], v14 offset:8192
    ds_read_b64_tr_b16 v[42:43], v14 offset:10240
    v_mfma_f32_16x16x32_bf16 v[232:235], v[168:171], v[24:27], v[232:235]
    ds_read_b64_tr_b16 v[44:45], v15 offset:8192
    ds_read_b64_tr_b16 v[46:47], v15 offset:10240
    v_mfma_f32_16x16x32_bf16 v[236:239], v[168:171], v[28:31], v[236:239]
    v_mfma_f32_16x16x32_bf16 v[240:243], v[172:175], v[16:19], v[240:243]
    v_mfma_f32_16x16x32_bf16 v[244:247], v[172:175], v[20:23], v[244:247]
    v_mfma_f32_16x16x32_bf16 v[248:251], v[172:175], v[24:27], v[248:251]
    v_mfma_f32_16x16x32_bf16 v[252:255], v[172:175], v[28:31], v[252:255]
    s_waitcnt vmcnt(7) lgkmcnt(0)
    v_mfma_f32_16x16x32_bf16 v[224:227], v[176:179], v[32:35], v[224:227]
    ds_read_b64_tr_b16 v[16:17], v12 offset:12288
    ds_read_b64_tr_b16 v[18:19], v12 offset:14336
    ds_read_b64_tr_b16 v[20:21], v13 offset:12288
    v_mfma_f32_16x16x32_bf16 v[228:231], v[176:179], v[36:39], v[228:231]
    ds_read_b64_tr_b16 v[22:23], v13 offset:14336
    ds_read_b64_tr_b16 v[24:25], v14 offset:12288
    ds_read_b64_tr_b16 v[26:27], v14 offset:14336
    v_mfma_f32_16x16x32_bf16 v[232:235], v[176:179], v[40:43], v[232:235]
    ds_read_b64_tr_b16 v[28:29], v15 offset:12288
    ds_read_b64_tr_b16 v[30:31], v15 offset:14336
    v_mfma_f32_16x16x32_bf16 v[236:239], v[176:179], v[44:47], v[236:239]
    v_mfma_f32_16x16x32_bf16 v[240:243], v[180:183], v[32:35], v[240:243]
    v_mfma_f32_16x16x32_bf16 v[244:247], v[180:183], v[36:39], v[244:247]
    v_mfma_f32_16x16x32_bf16 v[248:251], v[180:183], v[40:43], v[248:251]
    v_mfma_f32_16x16x32_bf16 v[252:255], v[180:183], v[44:47], v[252:255]
    s_waitcnt vmcnt(5) lgkmcnt(0)
    v_mfma_f32_16x16x32_bf16 v[224:227], v[184:187], v[16:19], v[224:227]
    v_mfma_f32_16x16x32_bf16 v[228:231], v[184:187], v[20:23], v[228:231]
    v_mfma_f32_16x16x32_bf16 v[232:235], v[184:187], v[24:27], v[232:235]
    v_mfma_f32_16x16x32_bf16 v[236:239], v[184:187], v[28:31], v[236:239]
    v_mfma_f32_16x16x32_bf16 v[240:243], v[188:191], v[16:19], v[240:243]
    v_mfma_f32_16x16x32_bf16 v[244:247], v[188:191], v[20:23], v[244:247]
    v_mfma_f32_16x16x32_bf16 v[248:251], v[188:191], v[24:27], v[248:251]
    v_mfma_f32_16x16x32_bf16 v[252:255], v[188:191], v[28:31], v[252:255]
    s_nop 4
    ds_write_b128 v3, v[240:243] offset:0
    ds_write_b128 v3, v[244:247] offset:1024
    ds_write_b128 v3, v[248:251] offset:2048
    ds_write_b128 v3, v[252:255] offset:3072
    s_cmp_lg_u32 s18, 0
    s_cbranch_scc1 EPK_13
POLL_14:
    buffer_load_dword v58, v57, s[68:71], 0 offen sc1
    s_waitcnt vmcnt(0)
    v_cmp_ne_u32 vcc, 1, v58
    s_cbranch_vccnz POLL_14
POLLD_15:
    s_mov_b32 s6, 0
    buffer_load_dwordx2 v[48:49], v55, s[64:67], s6 offen sc1
    s_mov_b32 s6, 65536
    buffer_load_dwordx2 v[50:51], v55, s[64:67], s6 offen sc1
    s_mov_b32 s6, 131072
    buffer_load_dwordx2 v[52:53], v55, s[64:67], s6 offen sc1
    s_mov_b32 s6, 196608
    buffer_load_dwordx2 v[54:55], v55, s[64:67], s6 offen sc1
    buffer_load_dwordx4 v[56:59], v56, s[68:71], 0 offen sc1
EPK_13:
    s_waitcnt lgkmcnt(0)
    s_barrier
    s_waitcnt vmcnt(0)
    v_lshlrev_b32 v28, 16, v56
    v_and_b32 v24, 0xffff0000, v56
    v_lshlrev_b32 v29, 16, v57
    v_and_b32 v25, 0xffff0000, v57
    v_lshlrev_b32 v30, 16, v58
    v_and_b32 v26, 0xffff0000, v58
    v_lshlrev_b32 v31, 16, v59
    v_and_b32 v27, 0xffff0000, v59
    v_lshlrev_b32 v32, 16, v48
    v_and_b32 v33, 0xffff0000, v48
    v_lshlrev_b32 v34, 16, v49
    v_and_b32 v35, 0xffff0000, v49
    v_lshlrev_b32 v36, 16, v50
    v_and_b32 v37, 0xffff0000, v50
    v_lshlrev_b32 v38, 16, v51
    v_and_b32 v39, 0xffff0000, v51
    v_lshlrev_b32 v40, 16, v52
    v_and_b32 v41, 0xffff0000, v52
    v_lshlrev_b32 v42, 16, v53
    v_and_b32 v43, 0xffff0000, v53
    v_lshlrev_b32 v44, 16, v54
    v_and_b32 v45, 0xffff0000, v54
    v_lshlrev_b32 v46, 16, v55
    v_and_b32 v47, 0xffff0000, v55
    v_pk_mul_f32 v[32:33], v[28:29], v[32:33]
    v_pk_mul_f32 v[34:35], v[30:31], v[34:35]
    v_pk_mul_f32 v[36:37], v[28:29], v[36:37]
    v_pk_mul_f32 v[38:39], v[30:31], v[38:39]
    v_pk_mul_f32 v[40:41], v[28:29], v[40:41]
    v_pk_mul_f32 v[42:43], v[30:31], v[42:43]
    v_pk_mul_f32 v[44:45], v[28:29], v[44:45]
    v_pk_mul_f32 v[46:47], v[30:31], v[46:47]
    v_pk_fma_f32 v[32:33], v[24:25], v[224:225], v[32:33]
    v_pk_fma_f32 v[34:35], v[26:27], v[226:227], v[34:35]
    v_pk_fma_f32 v[36:37], v[24:25], v[228:229], v[36:37]
    v_pk_fma_f32 v[38:39], v[26:27], v[230:231], v[38:39]
    v_pk_fma_f32 v[40:41], v[24:25], v[232:233], v[40:41]
    v_pk_fma_f32 v[42:43], v[26:27], v[234:235], v[42:43]
    v_pk_fma_f32 v[44:45], v[24:25], v[236:237], v[44:45]
    v_pk_fma_f32 v[46:47], v[26:27], v[238:239], v[46:47]
    s_barrier
    ds_read_b128 v[64:67], v4 offset:0
    ds_read_b128 v[68:71], v4 offset:1024
    ds_read_b128 v[72:75], v4 offset:2048
    ds_read_b128 v[76:79], v4 offset:3072
    s_waitcnt lgkmcnt(3)
    v_pk_fma_f32 v[64:65], v[24:25], v[64:65], v[32:33]
    v_pk_fma_f32 v[66:67], v[26:27], v[66:67], v[34:35]
    v_cvt_pk_bf16_f32 v80, v64, v65
    v_cvt_pk_bf16_f32 v81, v66, v67
    ds_write_b64 v7, v[80:81] offset:0
    s_waitcnt lgkmcnt(3)
    v_pk_fma_f32 v[68:69], v[24:25], v[68:69], v[36:37]
    v_pk_fma_f32 v[70:71], v[26:27], v[70:71], v[38:39]
    v_cvt_pk_bf16_f32 v82, v68, v69
    v_cvt_pk_bf16_f32 v83, v70, v71
    ds_write_b64 v7, v[82:83] offset:512
    s_waitcnt lgkmcnt(3)
    v_pk_fma_f32 v[72:73], v[24:25], v[72:73], v[40:41]
    v_pk_fma_f32 v[74:75], v[26:27], v[74:75], v[42:43]
    v_cvt_pk_bf16_f32 v84, v72, v73
    v_cvt_pk_bf16_f32 v85, v74, v75
    ds_write_b64 v7, v[84:85] offset:1024
    s_waitcnt lgkmcnt(3)
    v_pk_fma_f32 v[76:77], v[24:25], v[76:77], v[44:45]
    v_pk_fma_f32 v[78:79], v[26:27], v[78:79], v[46:47]
    v_cvt_pk_bf16_f32 v86, v76, v77
    v_cvt_pk_bf16_f32 v87, v78, v79
    ds_write_b64 v7, v[86:87] offset:1536
    ds_read_b64_tr_b16 v[16:17], v8 offset:0
    ds_read_b64_tr_b16 v[18:19], v9 offset:128
    ds_read_b64_tr_b16 v[20:21], v8 offset:1024
    ds_read_b64_tr_b16 v[22:23], v9 offset:1152
    s_waitcnt lgkmcnt(2)
    buffer_store_dwordx4 v[16:19], v5, s[72:75], 0 offen
    s_waitcnt lgkmcnt(0)
    buffer_store_dwordx4 v[20:23], v5, s[72:75], 0 offen offset:64
    s_endpgm
L_GATE:
    v_mov_b32 v7, 0
    v_lshlrev_b32 v10, 4, v0
    s_and_b32 s80, s5, 1
    s_lshl_b32 s6, s80, 15
    v_lshl_add_u32 v11, v0, 6, s6
    s_getpc_b64 s[12:13]
PC_16:
    s_sub_u32 s12, s12, PC_16-gated_mix__ssm_conv_s4__dense_activation_relu__prompt_kernel
    s_subb_u32 s13, s13, 0
    v_min_u32 v2, L_END-gated_mix__ssm_conv_s4__dense_activation_relu__prompt_kernel, v11
    v_mov_b32 v3, s13
    v_add_co_u32 v2, vcc, s12, v2
    s_nop 1
    v_addc_co_u32 v3, vcc, 0, v3, vcc
    global_load_dword v60, v[2:3], off
    v_and_b32 v12, 31, v1
    v_mul_u32_u24 v12, 1280, v12
    s_lshl_b32 s81, s80, 3
    s_add_u32 s81, s81, s3
    s_mov_b32 s82, 40960
    s_and_b32 s84, s4, 1
    s_mul_i32 s83, s4, 5
    s_lshr_b32 s83, s83, 2
    s_add_u32 s6, s81, 0
    s_lshl_b32 s6, s6, 6
    v_add_u32 v14, s6, v1
    v_mul_u32_u24 v15, 3277, v14
    v_lshrrev_b32 v15, 19, v15
    v_mul_u32_u24 v16, 160, v15
    v_sub_u32 v14, v14, v16
    v_lshrrev_b32 v14, 5, v14
    v_lshl_add_u32 v14, v14, 1, s84
    v_subrev_u32 v15, 0, v15
    v_mov_b32 v16, 0x1b4d0205
    v_mov_b32 v17, 0x9a3
    v_cmp_lt_u32 vcc, 4, v15
    s_nop 1
    v_cndmask_b32 v16, v16, v17, vcc
    v_subrev_u32 v17, 5, v15
    v_min_u32 v15, v15, v17
    v_mul_u32_u24 v15, 6, v15
    v_bfe_u32 v16, v16, v15, 6
    v_mul_u32_u24 v15, 5, v14
    v_min_u32 v15, 43, v15
    v_add_u32 v15, v16, v15
    v_subrev_u32 v16, 48, v15
    v_min_u32 v15, v15, v16
    v_mul_u32_u24 v15, s82, v15
    v_lshl_add_u32 v14, v14, 7, v12
    v_add_u32 v20, v14, v15
    s_add_u32 s6, s81, 16
    s_lshl_b32 s6, s6, 6
    v_add_u32 v14, s6, v1
    v_mul_u32_u24 v15, 3277, v14
    v_lshrrev_b32 v15, 19, v15
    v_mul_u32_u24 v16, 160, v15
    v_sub_u32 v14, v14, v16
    v_lshrrev_b32 v14, 5, v14
    v_lshl_add_u32 v14, v14, 1, s84
    v_subrev_u32 v15, 6, v15
    v_mov_b32 v16, 0x2040ba6
    v_mov_b32 v17, 0x103
    v_cmp_lt_u32 vcc, 4, v15
    s_nop 1
    v_cndmask_b32 v16, v16, v17, vcc
    v_subrev_u32 v17, 5, v15
    v_min_u32 v15, v15, v17
    v_mul_u32_u24 v15, 6, v15
    v_bfe_u32 v16, v16, v15, 6
    v_mul_u32_u24 v15, 5, v14
    v_min_u32 v15, 43, v15
    v_add_u32 v15, v16, v15
    v_subrev_u32 v16, 48, v15
    v_min_u32 v15, v15, v16
    v_mul_u32_u24 v15, s82, v15
    v_lshl_add_u32 v14, v14, 7, v12
    v_add_u32 v21, v14, v15
    s_add_u32 s6, s81, 32
    s_lshl_b32 s6, s6, 6
    v_add_u32 v14, s6, v1
    v_mul_u32_u24 v15, 3277, v14
    v_lshrrev_b32 v15, 19, v15
    v_mul_u32_u24 v16, 160, v15
    v_sub_u32 v14, v14, v16
    v_lshrrev_b32 v14, 5, v14
    v_lshl_add_u32 v14, v14, 1, s84
    v_subrev_u32 v15, 12, v15
    v_mov_b32 v16, 0x1650d2c4
    v_mov_b32 v17, 0x217d8
    v_cmp_lt_u32 vcc, 4, v15
    s_nop 1
    v_cndmask_b32 v16, v16, v17, vcc
    v_subrev_u32 v17, 5, v15
    v_min_u32 v15, v15, v17
    v_mul_u32_u24 v15, 6, v15
    v_bfe_u32 v16, v16, v15, 6
    v_mul_u32_u24 v15, 5, v14
    v_min_u32 v15, 43, v15
    v_add_u32 v15, v16, v15
    v_subrev_u32 v16, 48, v15
    v_min_u32 v15, v15, v16
    v_mul_u32_u24 v15, s82, v15
    v_lshl_add_u32 v14, v14, 7, v12
    v_add_u32 v22, v14, v15
    s_add_u32 s6, s81, 48
    s_lshl_b32 s6, s6, 6
    v_add_u32 v14, s6, v1
    v_mul_u32_u24 v15, 3277, v14
    v_lshrrev_b32 v15, 19, v15
    v_mul_u32_u24 v16, 160, v15
    v_sub_u32 v14, v14, v16
    v_lshrrev_b32 v14, 5, v14
    v_lshl_add_u32 v14, v14, 1, s84
    v_subrev_u32 v15, 19, v15
    v_mov_b32 v16, 0xe30aa21
    v_mov_b32 v17, 0x5d5
    v_cmp_lt_u32 vcc, 4, v15
    s_nop 1
    v_cndmask_b32 v16, v16, v17, vcc
    v_subrev_u32 v17, 5, v15
    v_min_u32 v15, v15, v17
    v_mul_u32_u24 v15, 6, v15
    v_bfe_u32 v16, v16, v15, 6
    v_mul_u32_u24 v15, 5, v14
    v_min_u32 v15, 43, v15
    v_add_u32 v15, v16, v15
    v_subrev_u32 v16, 48, v15
    v_min_u32 v15, v15, v16
    v_mul_u32_u24 v15, s82, v15
    v_lshl_add_u32 v14, v14, 7, v12
    v_add_u32 v23, v14, v15
    s_waitcnt lgkmcnt(0)
    s_add_u32 s68, s46, 0x880000
    s_addc_u32 s69, s47, 0
    s_mov_b32 s70, 0x10000
    s_mov_b32 s71, 0x20000
    s_mov_b32 s76, s44
    s_mov_b32 s77, s45
    s_mov_b32 s78, 0x100
    s_mov_b32 s79, 0x20000
    s_cmpk_lg_u32 s2, 160
    s_cbranch_scc1 SPN_17
    v_mov_b32 v40, 0
    v_mov_b32 v41, 0
    v_mov_b32 v42, 0
    v_mov_b32 v43, 0
    s_mov_b32 s6, 0x4000
    buffer_store_dwordx4 v[40:43], v10, s[68:71], s6 offen sc1
    s_mov_b32 s6, 0x6000
    buffer_store_dwordx4 v[40:43], v10, s[68:71], s6 offen sc1
    s_mov_b32 s6, 0x8000
    buffer_store_dwordx4 v[40:43], v10, s[68:71], s6 offen sc1
    s_mov_b32 s6, 0xa000
    buffer_store_dwordx4 v[40:43], v10, s[68:71], s6 offen sc1
    s_mov_b32 s6, 0xc000
    buffer_store_dwordx4 v[40:43], v10, s[68:71], s6 offen sc1
    s_mov_b32 s6, 0xe000
    buffer_store_dwordx4 v[40:43], v10, s[68:71], s6 offen sc1
    v_mov_b32 v8, 1
    s_waitcnt vmcnt(0)
    s_barrier
    s_cmp_lg_u32 s3, 0
    s_cbranch_scc1 SPN_17
    s_mov_b64 exec, 1
    buffer_store_dword v8, v7, s[76:79], 0 offen sc1
    s_mov_b64 exec, -1
SPN_17:
    s_waitcnt vmcnt(0)
    global_load_dword v20, v20, s[38:39]
    global_load_dword v21, v21, s[38:39]
    global_load_dword v22, v22, s[38:39]
    global_load_dword v23, v23, s[38:39]
    s_mov_b32 s48, s16
    s_mov_b32 s49, s17
    s_mov_b32 s50, 0x280000
    s_mov_b32 s51, 0x20000
    buffer_load_dword v6, v7, s[76:79], 0 offen sc1
    s_mov_b32 s52, s40
    s_mov_b32 s53, s41
    s_mov_b32 s54, 0x500
    s_mov_b32 s55, 0x20000
    v_and_b32 v2, 15, v1
    v_lshlrev_b32 v2, 4, v2
    v_lshrrev_b32 v3, 4, v1
    s_lshl_b32 s6, s10, 7
    s_lshl_b32 s7, s3, 4
    s_add_u32 s12, s6, s7
    v_add_u32 v4, s12, v3
    s_movk_i32 s6, 1280
    v_mul_u32_u24 v4, s6, v4
    v_add_u32 v4, v4, v2
    buffer_load_dwordx4 v[16:19], v2, s[52:55], 0 offen offset:0
    buffer_load_dwordx4 v[20:23], v2, s[52:55], 0 offen offset:256
    buffer_load_dwordx4 v[24:27], v2, s[52:55], 0 offen offset:512
    buffer_load_dwordx4 v[28:31], v2, s[52:55], 0 offen offset:768
    buffer_load_dwordx4 v[32:35], v2, s[52:55], 0 offen offset:1024
    s_mov_b32 s6, 0
    buffer_load_dwordx4 v[128:131], v4, s[48:51], s6 offen offset:0
    buffer_load_dwordx4 v[132:135], v4, s[48:51], s6 offen offset:256
    buffer_load_dwordx4 v[136:139], v4, s[48:51], s6 offen offset:512
    buffer_load_dwordx4 v[140:143], v4, s[48:51], s6 offen offset:768
    buffer_load_dwordx4 v[144:147], v4, s[48:51], s6 offen offset:1024
    s_mov_b32 s6, 5120
    buffer_load_dwordx4 v[148:151], v4, s[48:51], s6 offen offset:0
    buffer_load_dwordx4 v[152:155], v4, s[48:51], s6 offen offset:256
    buffer_load_dwordx4 v[156:159], v4, s[48:51], s6 offen offset:512
    buffer_load_dwordx4 v[160:163], v4, s[48:51], s6 offen offset:768
    buffer_load_dwordx4 v[164:167], v4, s[48:51], s6 offen offset:1024
    s_mov_b32 s6, 10240
    buffer_load_dwordx4 v[168:171], v4, s[48:51], s6 offen offset:0
    buffer_load_dwordx4 v[172:175], v4, s[48:51], s6 offen offset:256
    buffer_load_dwordx4 v[176:179], v4, s[48:51], s6 offen offset:512
    buffer_load_dwordx4 v[180:183], v4, s[48:51], s6 offen offset:768
    buffer_load_dwordx4 v[184:187], v4, s[48:51], s6 offen offset:1024
    s_mov_b32 s6, 15360
    buffer_load_dwordx4 v[188:191], v4, s[48:51], s6 offen offset:0
    buffer_load_dwordx4 v[192:195], v4, s[48:51], s6 offen offset:256
    buffer_load_dwordx4 v[196:199], v4, s[48:51], s6 offen offset:512
    buffer_load_dwordx4 v[200:203], v4, s[48:51], s6 offen offset:768
    buffer_load_dwordx4 v[204:207], v4, s[48:51], s6 offen offset:1024
    v_mov_b32 v8, 0
    v_mov_b32 v9, 0
    v_mov_b32 v10, 0
    v_mov_b32 v11, 0
    s_waitcnt vmcnt(15)
    v_dot2_f32_bf16 v8, v128, v16, v8
    v_dot2_f32_bf16 v8, v129, v17, v8
    v_dot2_f32_bf16 v8, v130, v18, v8
    v_dot2_f32_bf16 v8, v131, v19, v8
    v_dot2_f32_bf16 v8, v132, v20, v8
    v_dot2_f32_bf16 v8, v133, v21, v8
    v_dot2_f32_bf16 v8, v134, v22, v8
    v_dot2_f32_bf16 v8, v135, v23, v8
    v_dot2_f32_bf16 v8, v136, v24, v8
    v_dot2_f32_bf16 v8, v137, v25, v8
    v_dot2_f32_bf16 v8, v138, v26, v8
    v_dot2_f32_bf16 v8, v139, v27, v8
    v_dot2_f32_bf16 v8, v140, v28, v8
    v_dot2_f32_bf16 v8, v141, v29, v8
    v_dot2_f32_bf16 v8, v142, v30, v8
    v_dot2_f32_bf16 v8, v143, v31, v8
    v_dot2_f32_bf16 v8, v144, v32, v8
    v_dot2_f32_bf16 v8, v145, v33, v8
    v_dot2_f32_bf16 v8, v146, v34, v8
    v_dot2_f32_bf16 v8, v147, v35, v8
    s_waitcnt vmcnt(10)
    v_dot2_f32_bf16 v9, v148, v16, v9
    v_dot2_f32_bf16 v9, v149, v17, v9
    v_dot2_f32_bf16 v9, v150, v18, v9
    v_dot2_f32_bf16 v9, v151, v19, v9
    v_dot2_f32_bf16 v9, v152, v20, v9
    v_dot2_f32_bf16 v9, v153, v21, v9
    v_dot2_f32_bf16 v9, v154, v22, v9
    v_dot2_f32_bf16 v9, v155, v23, v9
    v_dot2_f32_bf16 v9, v156, v24, v9
    v_dot2_f32_bf16 v9, v157, v25, v9
    v_dot2_f32_bf16 v9, v158, v26, v9
    v_dot2_f32_bf16 v9, v159, v27, v9
    v_dot2_f32_bf16 v9, v160, v28, v9
    v_dot2_f32_bf16 v9, v161, v29, v9
    v_dot2_f32_bf16 v9, v162, v30, v9
    v_dot2_f32_bf16 v9, v163, v31, v9
    v_dot2_f32_bf16 v9, v164, v32, v9
    v_dot2_f32_bf16 v9, v165, v33, v9
    v_dot2_f32_bf16 v9, v166, v34, v9
    v_dot2_f32_bf16 v9, v167, v35, v9
    s_waitcnt vmcnt(5)
    v_dot2_f32_bf16 v10, v168, v16, v10
    v_dot2_f32_bf16 v10, v169, v17, v10
    v_dot2_f32_bf16 v10, v170, v18, v10
    v_dot2_f32_bf16 v10, v171, v19, v10
    v_dot2_f32_bf16 v10, v172, v20, v10
    v_dot2_f32_bf16 v10, v173, v21, v10
    v_dot2_f32_bf16 v10, v174, v22, v10
    v_dot2_f32_bf16 v10, v175, v23, v10
    v_dot2_f32_bf16 v10, v176, v24, v10
    v_dot2_f32_bf16 v10, v177, v25, v10
    v_dot2_f32_bf16 v10, v178, v26, v10
    v_dot2_f32_bf16 v10, v179, v27, v10
    v_dot2_f32_bf16 v10, v180, v28, v10
    v_dot2_f32_bf16 v10, v181, v29, v10
    v_dot2_f32_bf16 v10, v182, v30, v10
    v_dot2_f32_bf16 v10, v183, v31, v10
    v_dot2_f32_bf16 v10, v184, v32, v10
    v_dot2_f32_bf16 v10, v185, v33, v10
    v_dot2_f32_bf16 v10, v186, v34, v10
    v_dot2_f32_bf16 v10, v187, v35, v10
    s_waitcnt vmcnt(0)
    v_dot2_f32_bf16 v11, v188, v16, v11
    v_dot2_f32_bf16 v11, v189, v17, v11
    v_dot2_f32_bf16 v11, v190, v18, v11
    v_dot2_f32_bf16 v11, v191, v19, v11
    v_dot2_f32_bf16 v11, v192, v20, v11
    v_dot2_f32_bf16 v11, v193, v21, v11
    v_dot2_f32_bf16 v11, v194, v22, v11
    v_dot2_f32_bf16 v11, v195, v23, v11
    v_dot2_f32_bf16 v11, v196, v24, v11
    v_dot2_f32_bf16 v11, v197, v25, v11
    v_dot2_f32_bf16 v11, v198, v26, v11
    v_dot2_f32_bf16 v11, v199, v27, v11
    v_dot2_f32_bf16 v11, v200, v28, v11
    v_dot2_f32_bf16 v11, v201, v29, v11
    v_dot2_f32_bf16 v11, v202, v30, v11
    v_dot2_f32_bf16 v11, v203, v31, v11
    v_dot2_f32_bf16 v11, v204, v32, v11
    v_dot2_f32_bf16 v11, v205, v33, v11
    v_dot2_f32_bf16 v11, v206, v34, v11
    v_dot2_f32_bf16 v11, v207, v35, v11
    v_add_f32_dpp v8, v8, v8 row_ror:8 row_mask:0xf bank_mask:0xf
    v_add_f32_dpp v9, v9, v9 row_ror:8 row_mask:0xf bank_mask:0xf
    v_add_f32_dpp v10, v10, v10 row_ror:8 row_mask:0xf bank_mask:0xf
    v_add_f32_dpp v11, v11, v11 row_ror:8 row_mask:0xf bank_mask:0xf
    v_add_f32_dpp v8, v8, v8 row_ror:4 row_mask:0xf bank_mask:0xf
    v_add_f32_dpp v9, v9, v9 row_ror:4 row_mask:0xf bank_mask:0xf
    v_add_f32_dpp v10, v10, v10 row_ror:4 row_mask:0xf bank_mask:0xf
    v_add_f32_dpp v11, v11, v11 row_ror:4 row_mask:0xf bank_mask:0xf
    v_add_f32_dpp v8, v8, v8 row_ror:2 row_mask:0xf bank_mask:0xf
    v_add_f32_dpp v9, v9, v9 row_ror:2 row_mask:0xf bank_mask:0xf
    v_add_f32_dpp v10, v10, v10 row_ror:2 row_mask:0xf bank_mask:0xf
    v_add_f32_dpp v11, v11, v11 row_ror:2 row_mask:0xf bank_mask:0xf
    v_add_f32_dpp v8, v8, v8 row_ror:1 row_mask:0xf bank_mask:0xf
    v_add_f32_dpp v9, v9, v9 row_ror:1 row_mask:0xf bank_mask:0xf
    v_add_f32_dpp v10, v10, v10 row_ror:1 row_mask:0xf bank_mask:0xf
    v_add_f32_dpp v11, v11, v11 row_ror:1 row_mask:0xf bank_mask:0xf
    v_and_b32 v5, 3, v1
    v_cmp_eq_u32 vcc, 1, v5
    s_nop 1
    v_cndmask_b32 v8, v8, v9, vcc
    v_cmp_eq_u32 vcc, 2, v5
    s_nop 1
    v_cndmask_b32 v8, v8, v10, vcc
    v_cmp_eq_u32 vcc, 3, v5
    s_nop 1
    v_cndmask_b32 v8, v8, v11, vcc
    v_cvt_pk_bf16_f32 v8, v8, v8
    v_lshlrev_b32 v8, 16, v8
    v_mul_f32 v8, 0xbfb8aa3b, v8
    v_exp_f32 v8, v8
    s_nop 0
    v_add_f32 v8, 1.0, v8
    v_rcp_f32 v8, v8
    s_nop 0
    v_cvt_pk_bf16_f32 v8, v8, v8
    v_lshlrev_b32 v8, 16, v8
    v_sub_f32 v9, 1.0, v8
    v_cvt_pk_bf16_f32 v8, v8, v9
    v_lshl_add_u32 v5, v5, 2, v3
    v_add_u32 v5, s12, v5
    v_lshlrev_b32 v5, 2, v5
    buffer_store_dword v8, v5, s[68:71], 0 offen sc1
    s_waitcnt vmcnt(0)
    v_cmp_eq_u32 vcc, 1, v6
    s_cbranch_vccnz RDYD_20
RDY_19:
    buffer_load_dword v6, v7, s[76:79], 0 offen sc1
    s_waitcnt vmcnt(0)
    v_cmp_eq_u32 vcc, 1, v6
    s_cbranch_vccz RDY_19
RDYD_20:
    s_barrier
    s_cmp_lg_u32 s3, 0
    s_cbranch_scc1 GTE_18
    s_lshl_b32 s6, s10, 7
    s_add_u32 s6, s6, 43008
    s_add_u32 s7, s6, 0x4000
    v_mov_b32 v9, s7
    v_mov_b32 v8, 1
    s_mov_b64 exec, 1
    buffer_store_dword v8, v9, s[68:71], 0 offen sc1
    s_mov_b64 exec, -1
GTE_18:
    s_endpgm
L_CONV:
    s_mul_i32 s8, s4, 10
    s_add_u32 s8, s8, s5
    s_sub_u32 s8, s8, 22
    s_lshl_b32 s9, s8, 3
    s_add_u32 s9, s9, s3
    s_mul_i32 s6, s9, 384
    v_lshl_add_u32 v2, v1, 2, s6
    s_lshl_b32 s7, s9, 1
    v_mov_b32 v4, s7
    s_add_u32 s6, s6, 256
    v_lshl_add_u32 v3, v1, 1, s6
    s_waitcnt lgkmcnt(0)
    global_load_ushort v20, v4, s[30:31]
    global_load_dword v8, v2, s[18:19]
    global_load_dword v9, v2, s[20:21]
    global_load_dword v10, v2, s[22:23]
    global_load_dword v11, v2, s[24:25]
    global_load_dword v12, v2, s[26:27]
    global_load_dword v13, v2, s[28:29]
    global_load_ushort v14, v3, s[18:19]
    global_load_ushort v15, v3, s[20:21]
    global_load_ushort v16, v3, s[22:23]
    global_load_ushort v17, v3, s[24:25]
    global_load_ushort v18, v3, s[26:27]
    global_load_ushort v19, v3, s[28:29]
    global_load_ushort v21, v4, s[32:33]
    s_sub_u32 s12, s5, 22
    v_mov_b32 v2, 160640
    v_mov_b32 v6, 0
    v_mov_b32 v7, 0
    ds_write_b64 v2, v[6:7]
    s_waitcnt lgkmcnt(0)
    s_barrier
    s_cmp_lt_u32 s3, 4
    s_cbranch_scc1 CVF_21
    s_mul_i32 s83, s4, 5
    s_lshr_b32 s83, s83, 2
    s_lshl_b32 s80, s12, 2
    s_add_u32 s80, s80, s3
    s_sub_u32 s80, s80, 4
    s_add_u32 s14, s80, 92
    s_mul_i32 s6, s14, 2850
    s_lshr_b32 s6, s6, 16
    s_mul_i32 s7, s6, 23
    s_sub_u32 s7, s14, s7
    s_add_u32 s6, s6, s83
    s_cmp_ge_u32 s6, 10
    s_cselect_b32 s15, 10, 0
    s_sub_u32 s6, s6, s15
    s_lshl_b32 s15, s7, 6
    v_add_u32 v7, s15, v1
    s_and_b32 s13, s4, 6
    v_mul_u32_u24 v2, 4370, v7
    s_lshl2_add_u32 s13, s13, s7
    v_lshrrev_b32 v2, 16, v2
    s_sub_u32 s13, s13, 15
    v_mul_u32_u24 v3, 15, v2
    s_mul_i32 s13, s13, 81920
    v_sub_u32 v7, v7, v3
    s_mul_i32 s15, s6, 196608
    v_mul_u32_u24 v3, 86, v7
    s_lshl_b32 s6, s6, 7
    v_lshrrev_b32 v3, 8, v3
    s_add_u32 s13, s13, s6
    v_mad_i32_i24 v7, v3, -3, v7
    s_and_b32 s6, s4, 1
    s_lshl_b32 s6, s6, 1
    v_mad_u32_u24 v3, v3, 5, s6
    v_mul_u32_u24 v2, 3072, v2
    v_min_u32 v3, 21, v3
    s_cmp_ge_u32 s7, 15
    v_add_u32 v7, v7, v3
    s_cselect_b64 vcc, -1, 0
    v_lshl_add_u32 v7, v7, 7, v2
    s_cselect_b32 s56, 1, 0
    v_mul_u32_u24 v2, 1280, v1
    s_cmp_ge_u32 s14, 230
    v_add_u32 v7, s15, v7
    s_cselect_b32 s6, 2, 0
    v_add_u32 v2, s13, v2
    s_or_b32 s56, s56, s6
    v_cndmask_b32 v7, v7, v2, vcc
    s_bitcmp1_b32 s56, 0
    s_cselect_b64 s[6:7], s[16:17], s[36:37]
    s_bitcmp0_b32 s56, 1
    s_cselect_b64 exec, -1, 0
    global_load_dword v177, v7, s[6:7]
    s_mov_b64 exec, -1
    s_add_u32 s14, s80, 132
    s_mul_i32 s6, s14, 2850
    s_lshr_b32 s6, s6, 16
    s_mul_i32 s7, s6, 23
    s_sub_u32 s7, s14, s7
    s_add_u32 s6, s6, s83
    s_cmp_ge_u32 s6, 10
    s_cselect_b32 s15, 10, 0
    s_sub_u32 s6, s6, s15
    s_lshl_b32 s15, s7, 6
    v_add_u32 v7, s15, v1
    s_and_b32 s13, s4, 6
    v_mul_u32_u24 v2, 4370, v7
    s_lshl2_add_u32 s13, s13, s7
    v_lshrrev_b32 v2, 16, v2
    s_sub_u32 s13, s13, 15
    v_mul_u32_u24 v3, 15, v2
    s_mul_i32 s13, s13, 81920
    v_sub_u32 v7, v7, v3
    s_mul_i32 s15, s6, 196608
    v_mul_u32_u24 v3, 86, v7
    s_lshl_b32 s6, s6, 7
    v_lshrrev_b32 v3, 8, v3
    s_add_u32 s13, s13, s6
    v_mad_i32_i24 v7, v3, -3, v7
    s_and_b32 s6, s4, 1
    s_lshl_b32 s6, s6, 1
    v_mad_u32_u24 v3, v3, 5, s6
    v_mul_u32_u24 v2, 3072, v2
    v_min_u32 v3, 21, v3
    s_cmp_ge_u32 s7, 15
    v_add_u32 v7, v7, v3
    s_cselect_b64 vcc, -1, 0
    v_lshl_add_u32 v7, v7, 7, v2
    s_cselect_b32 s56, 1, 0
    v_mul_u32_u24 v2, 1280, v1
    s_cmp_ge_u32 s14, 230
    v_add_u32 v7, s15, v7
    s_cselect_b32 s6, 2, 0
    v_add_u32 v2, s13, v2
    s_or_b32 s56, s56, s6
    v_cndmask_b32 v7, v7, v2, vcc
    s_bitcmp1_b32 s56, 0
    s_cselect_b64 s[6:7], s[16:17], s[36:37]
    s_bitcmp0_b32 s56, 1
    s_cselect_b64 exec, -1, 0
    global_load_dword v177, v7, s[6:7]
    s_mov_b64 exec, -1
    v_subrev_u32 v6, 256, v0
    s_mul_i32 s6, s12, 205
    s_add_u32 s13, s6, 204
    s_min_u32 s13, s13, 0x7ff
    v_add_u32 v6, s6, v6
    v_min_u32 v6, s13, v6
    s_movk_i32 s6, 1280
    v_mul_u32_u24 v6, s6, v6
    s_mul_i32 s6, s4, 160
    s_and_b32 s6, s6, 0xffffff80
    v_add_u32 v6, s6, v6
    global_load_dword v177, v6, s[16:17]
    global_load_dword v177, v6, s[16:17] offset:128
    s_sub_u32 s13, s5, 22
    s_cmp_ge_u32 s13, 5
    s_cselect_b32 s7, 5, 0
    s_cselect_b64 vcc, -1, 0
    s_sub_u32 s13, s13, s7
    s_and_b32 s7, s4, 1
    s_lshl1_add_u32 s13, s13, s7
    s_mul_i32 s6, s13, 5
    s_min_u32 s6, s6, 43
    s_lshl_b32 s13, s13, 7
    v_and_b32 v6, 31, v0
    v_mul_u32_u24 v6, 1280, v6
    v_add_u32 v6, s13, v6
    v_bfe_u32 v7, v0, 5, 1
    v_lshlrev_b32 v7, 3, v7
    s_and_b32 s7, s3, 3
    s_lshl_b32 s7, s7, 4
    s_mov_b32 s13, 40960
    s_cmp_lg_u64 vcc, 0
    s_mov_b32 s14, 0x22201e17
    s_cselect_b32 s14, 0xf090706, s14
    s_mov_b32 s15, 0x2c2b2a29
    s_cselect_b32 s15, 0x1a191211, s15
    s_lshr_b64 s[14:15], s[14:15], s7
    v_bfe_u32 v178, s14, v7, 8
    v_add_u32 v178, s6, v178
    v_subrev_u32 v2, 48, v178
    v_min_u32 v178, v178, v2
    v_mad_u32_u24 v178, v178, s13, v6
    s_cmp_lg_u64 vcc, 0
    s_mov_b32 s14, 0x25241d1c
    s_cselect_b32 s14, 0x2f2f2f2f, s14
    s_mov_b32 s15, 0x2f2f2d27
    s_cselect_b32 s15, 0x2f2f2f2f, s15
    s_lshr_b64 s[14:15], s[14:15], s7
    v_bfe_u32 v179, s14, v7, 8
    v_add_u32 v179, s6, v179
    v_subrev_u32 v2, 48, v179
    v_min_u32 v179, v179, v2
    v_mad_u32_u24 v179, v179, s13, v6
    s_waitcnt vmcnt(4)
    s_branch CVC_22
CVF_21:
    s_setprio 1
    s_sub_u32 s13, s5, 22
    s_cmp_ge_u32 s13, 5
    s_cselect_b32 s7, 5, 0
    s_cselect_b64 vcc, -1, 0
    s_sub_u32 s13, s13, s7
    s_and_b32 s7, s4, 1
    s_lshl1_add_u32 s13, s13, s7
    s_mul_i32 s6, s13, 5
    s_min_u32 s6, s6, 43
    s_lshl_b32 s13, s13, 7
    v_and_b32 v6, 31, v0
    v_mul_u32_u24 v6, 1280, v6
    v_add_u32 v6, s13, v6
    v_bfe_u32 v7, v0, 5, 1
    v_lshlrev_b32 v7, 3, v7
    s_and_b32 s7, s3, 3
    s_lshl_b32 s7, s7, 4
    s_mov_b32 s13, 40960
    s_cmp_lg_u64 vcc, 0
    s_mov_b32 s14, 0x22201e17
    s_cselect_b32 s14, 0xf090706, s14
    s_mov_b32 s15, 0x2c2b2a29
    s_cselect_b32 s15, 0x1a191211, s15
    s_lshr_b64 s[14:15], s[14:15], s7
    v_bfe_u32 v178, s14, v7, 8
    v_add_u32 v178, s6, v178
    v_subrev_u32 v2, 48, v178
    v_min_u32 v178, v178, v2
    v_mad_u32_u24 v178, v178, s13, v6
    s_cmp_lg_u64 vcc, 0
    s_mov_b32 s14, 0x25241d1c
    s_cselect_b32 s14, 0x2f2f2f2f, s14
    s_mov_b32 s15, 0x2f2f2d27
    s_cselect_b32 s15, 0x2f2f2f2f, s15
    s_lshr_b64 s[14:15], s[14:15], s7
    v_bfe_u32 v179, s14, v7, 8
    v_add_u32 v179, s6, v179
    v_subrev_u32 v2, 48, v179
    v_min_u32 v179, v179, v2
    v_mad_u32_u24 v179, v179, s13, v6
CVC_22:
    s_movk_i32 s6, 10240
    v_mul_u32_u24 v5, s6, v0
    s_lshl_b32 s7, s8, 4
    v_add_u32 v5, s7, v5
    s_mul_i32 s10, s3, 4608
    s_add_u32 s10, s10, 119680
    v_mov_b32 v6, 0
    v_mov_b32 v7, 0
    v_mov_b32 v22, 0
    v_mov_b32 v23, 0
    v_lshl_add_u32 v2, v1, 3, s10
    ds_write_b64 v2, v[6:7] offset:4096
    s_mul_i32 s82, s3, 8704
    s_add_u32 s11, s82, 50048
    s_mul_i32 s81, s3, 6256
    s_mov_b32 m0, s82
    v_mov_b32 v4, 0x3f80
    ds_write_addtid_b32 v4 offset:50048
    s_and_b32 s6, s3, 3
    s_lshl_b32 s7, s6, 1
    s_add_u32 s7, s7, 3
    s_bfm_b32 s7, s7, 0
    s_lshl_b32 s13, s6, 3
    s_lshr_b32 s13, 0x17101512, s13
    s_and_b32 s13, s13, 0xff
    v_and_b32 v2, 15, v1
    v_sub_u32 v2, s13, v2
    v_lshlrev_b32 v2, v2, s7
    v_lshrrev_b32 v3, 4, v1
    v_lshlrev_b32 v3, 3, v3
    v_lshrrev_b32 v2, v3, v2
    s_mov_b32 s7, 0x10001
    s_movk_i32 s13, 0x3f80
    v_bfe_u32 v24, v2, 0, 2
    v_bfe_u32 v25, v2, 2, 2
    v_bfe_u32 v26, v2, 4, 2
    v_bfe_u32 v27, v2, 6, 2
    v_lshl_or_b32 v24, v24, 15, v24
    v_lshl_or_b32 v25, v25, 15, v25
    v_lshl_or_b32 v26, v26, 15, v26
    v_lshl_or_b32 v27, v27, 15, v27
    v_and_b32 v24, s7, v24
    v_and_b32 v25, s7, v25
    v_and_b32 v26, s7, v26
    v_and_b32 v27, s7, v27
    v_mul_u32_u24 v24, s13, v24
    v_mul_u32_u24 v25, s13, v25
    v_mul_u32_u24 v26, s13, v26
    v_mul_u32_u24 v27, s13, v27
    s_lshl_b32 s6, s6, 10
    s_add_u32 s6, s6, 156544
    v_lshl_add_u32 v2, v1, 4, s6
    ds_write_b128 v2, v[24:27]
    v_and_b32 v3, 31, v1
    s_movk_i32 s6, 272
    v_mul_u32_u24 v3, s6, v3
    v_lshrrev_b32 v4, 5, v1
    v_lshl_add_u32 v3, v4, 4, v3
    v_add_u32 v2, s11, v3
    v_add_u32 v3, s81, v3
    s_add_u32 s64, s46, 0x600000
    s_addc_u32 s65, s47, 0
    s_mov_b32 s66, 0x280000
    s_mov_b32 s67, 0x20000
    s_add_u32 s68, s46, 0x880000
    s_addc_u32 s69, s47, 0
    s_mov_b32 s70, 0x10000
    s_mov_b32 s71, 0x20000
    s_mov_b32 s76, s44
    s_mov_b32 s77, s45
    s_mov_b32 s78, 0x100
    s_mov_b32 s79, 0x20000
    s_mov_b32 s12, 0x3fb8aa3b
    s_mov_b32 s13, 0x32a57060
    s_mov_b32 s14, 0x43b8aa3b
    s_mov_b32 s15, 0x4222f983
    s_waitcnt vmcnt(13)
    v_lshlrev_b32 v20, 16, v20
    v_mul_f32 v22, s12, v20
    v_fma_f32 v23, v20, s12, -v22
    v_exp_f32 v22, v22
    v_fma_f32 v23, v20, s13, v23
    v_mul_f32 v23, 0x3f317218, v23
    v_fma_f32 v22, v22, v23, v22
    v_cvt_pk_bf16_f32 v22, v22, v22
    v_lshlrev_b32 v22, 16, v22
    s_waitcnt vmcnt(7)
    v_lshlrev_b32 v64, 16, v8
    v_and_b32 v70, 0xffff0000, v8
    v_lshlrev_b32 v65, 16, v9
    v_and_b32 v71, 0xffff0000, v9
    v_lshlrev_b32 v66, 16, v10
    v_and_b32 v72, 0xffff0000, v10
    v_lshlrev_b32 v67, 16, v11
    v_and_b32 v73, 0xffff0000, v11
    v_lshlrev_b32 v68, 16, v12
    v_and_b32 v74, 0xffff0000, v12
    v_lshlrev_b32 v69, 16, v13
    v_and_b32 v75, 0xffff0000, v13
    s_cmp_ge_u32 s3, 4
    s_cbranch_scc1 CVT_23
    s_waitcnt vmcnt(0)
CVT_23:
    v_lshlrev_b32 v76, 16, v14
    v_lshlrev_b32 v77, 16, v15
    v_lshlrev_b32 v78, 16, v16
    v_lshlrev_b32 v79, 16, v17
    v_lshlrev_b32 v80, 16, v18
    v_lshlrev_b32 v81, 16, v19
    v_pk_mul_f32 v[64:65], v[22:23], v[64:65] op_sel_hi:[0,1]
    v_pk_mul_f32 v[66:67], v[22:23], v[66:67] op_sel_hi:[0,1]
    v_pk_mul_f32 v[70:71], v[22:23], v[70:71] op_sel_hi:[0,1]
    v_pk_mul_f32 v[72:73], v[22:23], v[72:73] op_sel_hi:[0,1]
    v_pk_mul_f32 v[76:77], v[22:23], v[76:77] op_sel_hi:[0,1]
    v_pk_mul_f32 v[78:79], v[22:23], v[78:79] op_sel_hi:[0,1]
    v_mul_f32 v84, s12, v64
    v_mul_f32 v86, s14, v64
    v_mul_f32 v88, 0.15915494, v65
    v_mul_f32 v89, s15, v65
    v_mul_f32 v94, s12, v70
    v_mul_f32 v96, s14, v70
    v_mul_f32 v98, 0.15915494, v71
    v_mul_f32 v99, s15, v71
    v_mul_f32 v104, s12, v76
    v_mul_f32 v106, s14, v76
    v_mul_f32 v108, 0.15915494, v77
    v_mul_f32 v109, s15, v77
    v_rndne_f32 v90, v88
    v_rndne_f32 v91, v89
    v_exp_f32 v84, v84
    v_exp_f32 v86, v86
    v_sub_f32 v88, v88, v90
    v_sub_f32 v89, v89, v91
    v_rndne_f32 v100, v98
    v_rndne_f32 v101, v99
    v_exp_f32 v94, v94
    v_exp_f32 v96, v96
    v_sub_f32 v98, v98, v100
    v_sub_f32 v99, v99, v101
    v_rndne_f32 v110, v108
    v_rndne_f32 v111, v109
    v_exp_f32 v104, v104
    v_exp_f32 v106, v106
    v_sub_f32 v108, v108, v110
    v_sub_f32 v109, v109, v111
    v_cos_f32 v90, v88
    v_pk_mul_f32 v[40:41], v[68:69], v[66:67] op_sel_hi:[0,1]
    v_sin_f32 v91, v88
    v_pk_fma_f32 v[40:41], v[68:69], v[66:67], v[40:41] op_sel:[1,1,0] op_sel_hi:[1,0,1] neg_lo:[1,0,0]
    v_cos_f32 v92, v89
    v_sin_f32 v93, v89
    v_cos_f32 v100, v98
    v_pk_mul_f32 v[46:47], v[74:75], v[72:73] op_sel_hi:[0,1]
    v_sin_f32 v101, v98
    v_pk_fma_f32 v[46:47], v[74:75], v[72:73], v[46:47] op_sel:[1,1,0] op_sel_hi:[1,0,1] neg_lo:[1,0,0]
    v_cos_f32 v102, v99
    v_sin_f32 v103, v99
    v_cos_f32 v110, v108
    v_pk_mul_f32 v[52:53], v[80:81], v[78:79] op_sel_hi:[0,1]
    v_sin_f32 v111, v108
    v_pk_fma_f32 v[52:53], v[80:81], v[78:79], v[52:53] op_sel:[1,1,0] op_sel_hi:[1,0,1] neg_lo:[1,0,0]
    v_cos_f32 v112, v109
    v_sin_f32 v113, v109
    v_pk_mul_f32 v[42:43], v[84:85], v[90:91] op_sel_hi:[0,1]
    v_pk_mul_f32 v[44:45], v[86:87], v[92:93] op_sel_hi:[0,1]
    v_pk_mul_f32 v[48:49], v[94:95], v[100:101] op_sel_hi:[0,1]
    v_pk_mul_f32 v[50:51], v[96:97], v[102:103] op_sel_hi:[0,1]
    v_pk_mul_f32 v[54:55], v[104:105], v[110:111] op_sel_hi:[0,1]
    v_pk_mul_f32 v[56:57], v[106:107], v[112:113] op_sel_hi:[0,1]
    v_pk_mul_f32 v[58:59], v[42:43], v[42:43] op_sel_hi:[0,1]
    v_pk_fma_f32 v[58:59], v[42:43], v[42:43], v[58:59] op_sel:[1,1,0] op_sel_hi:[1,0,1] neg_lo:[1,0,0]
    v_pk_mul_f32 v[60:61], v[58:59], v[58:59] op_sel_hi:[0,1]
    v_pk_fma_f32 v[60:61], v[58:59], v[58:59], v[60:61] op_sel:[1,1,0] op_sel_hi:[1,0,1] neg_lo:[1,0,0]
    v_pk_mul_f32 v[114:115], v[60:61], v[60:61] op_sel_hi:[0,1] neg_hi:[1,0]
    v_pk_mul_f32 v[72:73], v[40:41], v[60:61] op_sel_hi:[0,1]
    v_pk_mul_f32 v[68:69], v[40:41], v[58:59] op_sel_hi:[0,1]
    v_pk_mul_f32 v[66:67], v[40:41], v[42:43] op_sel_hi:[0,1]
    v_pk_fma_f32 v[114:115], v[60:61], v[60:61], v[114:115] op_sel:[1,1,0] op_sel_hi:[1,0,1] neg_lo:[1,0,0] neg_hi:[1,0,0]
    v_pk_fma_f32 v[72:73], v[40:41], v[60:61], v[72:73] op_sel:[1,1,0] op_sel_hi:[1,0,1] neg_lo:[1,0,0]
    v_pk_fma_f32 v[68:69], v[40:41], v[58:59], v[68:69] op_sel:[1,1,0] op_sel_hi:[1,0,1] neg_lo:[1,0,0]
    v_pk_fma_f32 v[66:67], v[40:41], v[42:43], v[66:67] op_sel:[1,1,0] op_sel_hi:[1,0,1] neg_lo:[1,0,0]
    v_pk_mul_f32 v[108:109], v[72:73], v[60:61] op_sel_hi:[0,1]
    v_pk_mul_f32 v[116:117], v[114:115], v[114:115] op_sel_hi:[0,1]
    v_pk_mul_f32 v[82:83], v[72:73], v[44:45] op_sel_hi:[0,1]
    v_pk_mul_f32 v[70:71], v[66:67], v[58:59] op_sel_hi:[0,1]
    v_pk_mul_f32 v[74:75], v[66:67], v[60:61] op_sel_hi:[0,1]
    v_pk_mul_f32 v[76:77], v[68:69], v[60:61] op_sel_hi:[0,1]
    v_pk_mul_f32 v[80:81], v[68:69], v[44:45] op_sel_hi:[0,1]
    v_pk_fma_f32 v[108:109], v[72:73], v[60:61], v[108:109] op_sel:[1,1,0] op_sel_hi:[1,0,1] neg_lo:[1,0,0]
    v_pk_fma_f32 v[116:117], v[114:115], v[114:115], v[116:117] op_sel:[1,1,0] op_sel_hi:[1,0,1] neg_lo:[1,0,0]
    v_pk_fma_f32 v[82:83], v[72:73], v[44:45], v[82:83] op_sel:[1,1,0] op_sel_hi:[1,0,1] neg_lo:[1,0,0]
    v_pk_fma_f32 v[70:71], v[66:67], v[58:59], v[70:71] op_sel:[1,1,0] op_sel_hi:[1,0,1] neg_lo:[1,0,0]
    v_pk_fma_f32 v[74:75], v[66:67], v[60:61], v[74:75] op_sel:[1,1,0] op_sel_hi:[1,0,1] neg_lo:[1,0,0]
    v_pk_fma_f32 v[76:77], v[68:69], v[60:61], v[76:77] op_sel:[1,1,0] op_sel_hi:[1,0,1] neg_lo:[1,0,0]
    v_pk_fma_f32 v[80:81], v[68:69], v[44:45], v[80:81] op_sel:[1,1,0] op_sel_hi:[1,0,1] neg_lo:[1,0,0]
    v_pk_mul_f32 v[90:91], v[108:109], v[44:45] op_sel_hi:[0,1]
    v_pk_mul_f32 v[120:121], v[116:117], v[116:117] op_sel_hi:[0,1]
    v_pk_mul_f32 v[118:119], v[116:117], v[114:115] op_sel_hi:[0,1]
    v_pk_mul_f32 v[84:85], v[82:83], v[44:45] op_sel_hi:[0,1]
    v_pk_mul_f32 v[78:79], v[70:71], v[60:61] op_sel_hi:[0,1]
    v_pk_mul_f32 v[88:89], v[76:77], v[44:45] op_sel_hi:[0,1]
    v_pk_fma_f32 v[90:91], v[108:109], v[44:45], v[90:91] op_sel:[1,1,0] op_sel_hi:[1,0,1] neg_lo:[1,0,0]
    v_pk_fma_f32 v[120:121], v[116:117], v[116:117], v[120:121] op_sel:[1,1,0] op_sel_hi:[1,0,1] neg_lo:[1,0,0]
    v_pk_fma_f32 v[118:119], v[116:117], v[114:115], v[118:119] op_sel:[1,1,0] op_sel_hi:[1,0,1] neg_lo:[1,0,0]
    v_pk_fma_f32 v[84:85], v[82:83], v[44:45], v[84:85] op_sel:[1,1,0] op_sel_hi:[1,0,1] neg_lo:[1,0,0]
    v_pk_fma_f32 v[78:79], v[70:71], v[60:61], v[78:79] op_sel:[1,1,0] op_sel_hi:[1,0,1] neg_lo:[1,0,0]
    v_pk_fma_f32 v[88:89], v[76:77], v[44:45], v[88:89] op_sel:[1,1,0] op_sel_hi:[1,0,1] neg_lo:[1,0,0]
    v_pk_mul_f32 v[86:87], v[90:91], v[44:45] op_sel_hi:[0,1]
    v_pk_mul_f32 v[128:129], v[120:121], v[120:121] op_sel_hi:[0,1]
    v_pk_mul_f32 v[92:93], v[84:85], v[44:45] op_sel_hi:[0,1]
    v_pk_mul_f32 v[122:123], v[120:121], v[114:115] op_sel_hi:[0,1]
    v_pk_mul_f32 v[124:125], v[120:121], v[116:117] op_sel_hi:[0,1]
    v_pk_mul_f32 v[126:127], v[120:121], v[118:119] op_sel_hi:[0,1]
    v_pk_fma_f32 v[86:87], v[90:91], v[44:45], v[86:87] op_sel:[1,1,0] op_sel_hi:[1,0,1] neg_lo:[1,0,0]
    v_pk_fma_f32 v[128:129], v[120:121], v[120:121], v[128:129] op_sel:[1,1,0] op_sel_hi:[1,0,1] neg_lo:[1,0,0]
    v_pk_fma_f32 v[92:93], v[84:85], v[44:45], v[92:93] op_sel:[1,1,0] op_sel_hi:[1,0,1] neg_lo:[1,0,0]
    v_pk_fma_f32 v[122:123], v[120:121], v[114:115], v[122:123] op_sel:[1,1,0] op_sel_hi:[1,0,1] neg_lo:[1,0,0]
    v_pk_fma_f32 v[124:125], v[120:121], v[116:117], v[124:125] op_sel:[1,1,0] op_sel_hi:[1,0,1] neg_lo:[1,0,0]
    v_pk_fma_f32 v[126:127], v[120:121], v[118:119], v[126:127] op_sel:[1,1,0] op_sel_hi:[1,0,1] neg_lo:[1,0,0]
    v_pk_mul_f32 v[94:95], v[86:87], v[44:45] op_sel_hi:[0,1]
    v_pk_mul_f32 v[144:145], v[128:129], v[128:129] op_sel_hi:[0,1]
    v_pk_mul_f32 v[130:131], v[128:129], v[114:115] op_sel_hi:[0,1]
    v_pk_mul_f32 v[132:133], v[128:129], v[116:117] op_sel_hi:[0,1]
    v_pk_mul_f32 v[134:135], v[128:129], v[118:119] op_sel_hi:[0,1]
    v_pk_mul_f32 v[136:137], v[128:129], v[120:121] op_sel_hi:[0,1]
    v_pk_mul_f32 v[138:139], v[128:129], v[122:123] op_sel_hi:[0,1]
    v_pk_fma_f32 v[94:95], v[86:87], v[44:45], v[94:95] op_sel:[1,1,0] op_sel_hi:[1,0,1] neg_lo:[1,0,0]
    v_pk_fma_f32 v[144:145], v[128:129], v[128:129], v[144:145] op_sel:[1,1,0] op_sel_hi:[1,0,1] neg_lo:[1,0,0]
    v_pk_fma_f32 v[130:131], v[128:129], v[114:115], v[130:131] op_sel:[1,1,0] op_sel_hi:[1,0,1] neg_lo:[1,0,0]
    v_pk_fma_f32 v[132:133], v[128:129], v[116:117], v[132:133] op_sel:[1,1,0] op_sel_hi:[1,0,1] neg_lo:[1,0,0]
    v_pk_fma_f32 v[134:135], v[128:129], v[118:119], v[134:135] op_sel:[1,1,0] op_sel_hi:[1,0,1] neg_lo:[1,0,0]
    v_pk_fma_f32 v[136:137], v[128:129], v[120:121], v[136:137] op_sel:[1,1,0] op_sel_hi:[1,0,1] neg_lo:[1,0,0]
    v_pk_fma_f32 v[138:139], v[128:129], v[122:123], v[138:139] op_sel:[1,1,0] op_sel_hi:[1,0,1] neg_lo:[1,0,0]
    v_pk_mul_f32 v[96:97], v[94:95], v[44:45] op_sel_hi:[0,1]
    v_pk_mul_f32 v[140:141], v[128:129], v[124:125] op_sel_hi:[0,1]
    v_pk_mul_f32 v[142:143], v[128:129], v[126:127] op_sel_hi:[0,1]
    v_pk_mul_f32 v[146:147], v[144:145], v[114:115] op_sel_hi:[0,1]
    v_pk_mul_f32 v[148:149], v[144:145], v[116:117] op_sel_hi:[0,1]
    v_pk_mul_f32 v[150:151], v[144:145], v[118:119] op_sel_hi:[0,1]
    v_pk_fma_f32 v[96:97], v[94:95], v[44:45], v[96:97] op_sel:[1,1,0] op_sel_hi:[1,0,1] neg_lo:[1,0,0]
    v_pk_fma_f32 v[140:141], v[128:129], v[124:125], v[140:141] op_sel:[1,1,0] op_sel_hi:[1,0,1] neg_lo:[1,0,0]
    v_pk_fma_f32 v[142:143], v[128:129], v[126:127], v[142:143] op_sel:[1,1,0] op_sel_hi:[1,0,1] neg_lo:[1,0,0]
    v_pk_fma_f32 v[146:147], v[144:145], v[114:115], v[146:147] op_sel:[1,1,0] op_sel_hi:[1,0,1] neg_lo:[1,0,0]
    v_pk_fma_f32 v[148:149], v[144:145], v[116:117], v[148:149] op_sel:[1,1,0] op_sel_hi:[1,0,1] neg_lo:[1,0,0]
    v_pk_fma_f32 v[150:151], v[144:145], v[118:119], v[150:151] op_sel:[1,1,0] op_sel_hi:[1,0,1] neg_lo:[1,0,0]
    v_pk_mul_f32 v[104:105], v[96:97], v[44:45] op_sel_hi:[0,1]
    v_pk_mul_f32 v[152:153], v[144:145], v[120:121] op_sel_hi:[0,1]
    v_pk_mul_f32 v[154:155], v[144:145], v[122:123] op_sel_hi:[0,1]
    v_pk_mul_f32 v[156:157], v[144:145], v[124:125] op_sel_hi:[0,1]
    v_pk_mul_f32 v[158:159], v[144:145], v[126:127] op_sel_hi:[0,1]
    v_pk_fma_f32 v[104:105], v[96:97], v[44:45], v[104:105] op_sel:[1,1,0] op_sel_hi:[1,0,1] neg_lo:[1,0,0]
    v_pk_fma_f32 v[152:153], v[144:145], v[120:121], v[152:153] op_sel:[1,1,0] op_sel_hi:[1,0,1] neg_lo:[1,0,0]
    v_pk_fma_f32 v[154:155], v[144:145], v[122:123], v[154:155] op_sel:[1,1,0] op_sel_hi:[1,0,1] neg_lo:[1,0,0]
    v_pk_fma_f32 v[156:157], v[144:145], v[124:125], v[156:157] op_sel:[1,1,0] op_sel_hi:[1,0,1] neg_lo:[1,0,0]
    v_pk_fma_f32 v[158:159], v[144:145], v[126:127], v[158:159] op_sel:[1,1,0] op_sel_hi:[1,0,1] neg_lo:[1,0,0]
    v_pk_mul_f32 v[98:99], v[104:105], v[44:45] op_sel_hi:[0,1]
    v_pk_mul_f32 v[160:161], v[144:145], v[128:129] op_sel_hi:[0,1]
    v_pk_mul_f32 v[162:163], v[144:145], v[130:131] op_sel_hi:[0,1]
    v_pk_mul_f32 v[164:165], v[144:145], v[132:133] op_sel_hi:[0,1]
    v_pk_mul_f32 v[166:167], v[144:145], v[134:135] op_sel_hi:[0,1]
    v_pk_fma_f32 v[98:99], v[104:105], v[44:45], v[98:99] op_sel:[1,1,0] op_sel_hi:[1,0,1] neg_lo:[1,0,0]
    v_pk_fma_f32 v[160:161], v[144:145], v[128:129], v[160:161] op_sel:[1,1,0] op_sel_hi:[1,0,1] neg_lo:[1,0,0]
    v_pk_fma_f32 v[162:163], v[144:145], v[130:131], v[162:163] op_sel:[1,1,0] op_sel_hi:[1,0,1] neg_lo:[1,0,0]
    v_pk_fma_f32 v[164:165], v[144:145], v[132:133], v[164:165] op_sel:[1,1,0] op_sel_hi:[1,0,1] neg_lo:[1,0,0]
    v_pk_fma_f32 v[166:167], v[144:145], v[134:135], v[166:167] op_sel:[1,1,0] op_sel_hi:[1,0,1] neg_lo:[1,0,0]
    v_pk_mul_f32 v[106:107], v[98:99], v[44:45] op_sel_hi:[0,1]
    v_pk_mul_f32 v[168:169], v[144:145], v[136:137] op_sel_hi:[0,1]
    v_pk_mul_f32 v[170:171], v[144:145], v[138:139] op_sel_hi:[0,1]
    v_pk_mul_f32 v[172:173], v[144:145], v[140:141] op_sel_hi:[0,1]
    v_pk_mul_f32 v[174:175], v[144:145], v[142:143] op_sel_hi:[0,1]
    v_pk_fma_f32 v[106:107], v[98:99], v[44:45], v[106:107] op_sel:[1,1,0] op_sel_hi:[1,0,1] neg_lo:[1,0,0]
    v_pk_fma_f32 v[168:169], v[144:145], v[136:137], v[168:169] op_sel:[1,1,0] op_sel_hi:[1,0,1] neg_lo:[1,0,0]
    v_pk_fma_f32 v[170:171], v[144:145], v[138:139], v[170:171] op_sel:[1,1,0] op_sel_hi:[1,0,1] neg_lo:[1,0,0]
    v_pk_fma_f32 v[172:173], v[144:145], v[140:141], v[172:173] op_sel:[1,1,0] op_sel_hi:[1,0,1] neg_lo:[1,0,0]
    v_pk_fma_f32 v[174:175], v[144:145], v[142:143], v[174:175] op_sel:[1,1,0] op_sel_hi:[1,0,1] neg_lo:[1,0,0]
    v_cvt_pk_bf16_f32 v176, v40, v41
    v_cvt_pk_bf16_f32 v66, v66, v67
    v_cvt_pk_bf16_f32 v68, v68, v69
    v_cvt_pk_bf16_f32 v70, v70, v71
    v_cvt_pk_bf16_f32 v72, v72, v73
    v_cvt_pk_bf16_f32 v74, v74, v75
    v_cvt_pk_bf16_f32 v76, v76, v77
    v_cvt_pk_bf16_f32 v78, v78, v79
    v_cvt_pk_bf16_f32 v80, v80, v81
    v_cvt_pk_bf16_f32 v82, v82, v83
    v_cvt_pk_bf16_f32 v84, v84, v85
    v_cvt_pk_bf16_f32 v86, v86, v87
    v_cvt_pk_bf16_f32 v88, v88, v89
    v_pk_mul_f32 v[58:59], v[48:49], v[48:49] op_sel_hi:[0,1]
    s_mov_b32 m0, s81
    s_nop 0
    ds_write_addtid_b32 v176 offset:0
    ds_write_addtid_b32 v66 offset:272
    ds_write_addtid_b32 v68 offset:544
    ds_write_addtid_b32 v70 offset:816
    ds_write_addtid_b32 v72 offset:1088
    ds_write_addtid_b32 v74 offset:1360
    v_cvt_pk_bf16_f32 v90, v90, v91
    v_cvt_pk_bf16_f32 v92, v92, v93
    v_cvt_pk_bf16_f32 v94, v94, v95
    v_cvt_pk_bf16_f32 v96, v96, v97
    v_cvt_pk_bf16_f32 v98, v98, v99
    v_cvt_pk_bf16_f32 v104, v104, v105
    ds_write_addtid_b32 v76 offset:1632
    ds_write_addtid_b32 v78 offset:1904
    ds_write_addtid_b32 v80 offset:2176
    ds_write_addtid_b32 v82 offset:2448
    ds_write_addtid_b32 v84 offset:2720
    ds_write_addtid_b32 v86 offset:2992
    ds_write_addtid_b32 v88 offset:3264
    v_cvt_pk_bf16_f32 v106, v106, v107
    v_cvt_pk_bf16_f32 v108, v108, v109
    v_cvt_pk_bf16_f32 v114, v114, v115
    v_cvt_pk_bf16_f32 v116, v116, v117
    v_cvt_pk_bf16_f32 v118, v118, v119
    v_cvt_pk_bf16_f32 v120, v120, v121
    v_cvt_pk_bf16_f32 v122, v122, v123
    v_pk_fma_f32 v[58:59], v[48:49], v[48:49], v[58:59] op_sel:[1,1,0] op_sel_hi:[1,0,1] neg_lo:[1,0,0]
    ds_write_addtid_b32 v90 offset:3536
    ds_write_addtid_b32 v92 offset:3808
    ds_write_addtid_b32 v94 offset:4080
    ds_write_addtid_b32 v96 offset:4352
    ds_write_addtid_b32 v98 offset:4624
    ds_write_addtid_b32 v104 offset:5440
    v_cvt_pk_bf16_f32 v124, v124, v125
    v_cvt_pk_bf16_f32 v126, v126, v127
    v_cvt_pk_bf16_f32 v128, v128, v129
    v_cvt_pk_bf16_f32 v130, v130, v131
    v_cvt_pk_bf16_f32 v132, v132, v133
    v_cvt_pk_bf16_f32 v134, v134, v135
    ds_write_addtid_b32 v106 offset:5712
    ds_write_addtid_b32 v108 offset:5984
    s_mov_b32 m0, s82
    s_nop 0
    ds_write_addtid_b32 v114 offset:50320
    ds_write_addtid_b32 v116 offset:50592
    ds_write_addtid_b32 v118 offset:50864
    ds_write_addtid_b32 v120 offset:51136
    ds_write_addtid_b32 v122 offset:51408
    v_cvt_pk_bf16_f32 v136, v136, v137
    v_cvt_pk_bf16_f32 v138, v138, v139
    v_cvt_pk_bf16_f32 v140, v140, v141
    v_cvt_pk_bf16_f32 v142, v142, v143
    v_cvt_pk_bf16_f32 v144, v144, v145
    v_cvt_pk_bf16_f32 v146, v146, v147
    v_cvt_pk_bf16_f32 v148, v148, v149
    v_pk_mul_f32 v[60:61], v[58:59], v[58:59] op_sel_hi:[0,1]
    ds_write_addtid_b32 v124 offset:51680
    ds_write_addtid_b32 v126 offset:51952
    ds_write_addtid_b32 v128 offset:52224
    ds_write_addtid_b32 v130 offset:52496
    ds_write_addtid_b32 v132 offset:52768
    ds_write_addtid_b32 v134 offset:53040
    v_cvt_pk_bf16_f32 v150, v150, v151
    v_cvt_pk_bf16_f32 v152, v152, v153
    v_cvt_pk_bf16_f32 v154, v154, v155
    v_cvt_pk_bf16_f32 v156, v156, v157
    v_cvt_pk_bf16_f32 v158, v158, v159
    v_cvt_pk_bf16_f32 v160, v160, v161
    ds_write_addtid_b32 v136 offset:53312
    ds_write_addtid_b32 v138 offset:53584
    ds_write_addtid_b32 v140 offset:53856
    ds_write_addtid_b32 v142 offset:54128
    ds_write_addtid_b32 v144 offset:54400
    ds_write_addtid_b32 v146 offset:54672
    ds_write_addtid_b32 v148 offset:54944
    v_cvt_pk_bf16_f32 v162, v162, v163
    v_cvt_pk_bf16_f32 v164, v164, v165
    v_cvt_pk_bf16_f32 v166, v166, v167
    v_cvt_pk_bf16_f32 v168, v168, v169
    v_cvt_pk_bf16_f32 v170, v170, v171
    v_cvt_pk_bf16_f32 v172, v172, v173
    v_cvt_pk_bf16_f32 v174, v174, v175
    v_pk_fma_f32 v[60:61], v[58:59], v[58:59], v[60:61] op_sel:[1,1,0] op_sel_hi:[1,0,1] neg_lo:[1,0,0]
    ds_write_addtid_b32 v150 offset:55216
    ds_write_addtid_b32 v152 offset:55488
    ds_write_addtid_b32 v154 offset:55760
    ds_write_addtid_b32 v156 offset:56032
    ds_write_addtid_b32 v158 offset:56304
    ds_write_addtid_b32 v160 offset:56576
    ds_write_addtid_b32 v162 offset:56848
    ds_write_addtid_b32 v164 offset:57120
    ds_write_addtid_b32 v166 offset:57392
    ds_write_addtid_b32 v168 offset:57664
    ds_write_addtid_b32 v170 offset:57936
    ds_write_addtid_b32 v172 offset:58208
    ds_write_addtid_b32 v174 offset:58480
    ds_read_b128 v[192:195], v3 offset:0
    ds_read_b128 v[196:199], v2 offset:0
    ds_read_b128 v[200:203], v3 offset:32
    ds_read_b128 v[204:207], v2 offset:32
    ds_read_b128 v[208:211], v3 offset:64
    ds_read_b128 v[212:215], v2 offset:64
    ds_read_b128 v[216:219], v3 offset:96
    ds_read_b128 v[220:223], v2 offset:96
    ds_read_b128 v[224:227], v3 offset:128
    ds_read_b128 v[228:231], v2 offset:128
    ds_read_b128 v[24:27], v3 offset:160
    ds_read_b128 v[28:31], v2 offset:160
    ds_read_b128 v[32:35], v3 offset:192
    ds_read_b128 v[36:39], v2 offset:192
    ds_read_b128 v[8:11], v3 offset:224
    ds_read_b128 v[12:15], v2 offset:224
    v_pk_mul_f32 v[114:115], v[60:61], v[60:61] op_sel_hi:[0,1] neg_hi:[1,0]
    v_pk_mul_f32 v[72:73], v[46:47], v[60:61] op_sel_hi:[0,1]
    v_pk_mul_f32 v[68:69], v[46:47], v[58:59] op_sel_hi:[0,1]
    v_pk_mul_f32 v[66:67], v[46:47], v[48:49] op_sel_hi:[0,1]
    v_pk_fma_f32 v[114:115], v[60:61], v[60:61], v[114:115] op_sel:[1,1,0] op_sel_hi:[1,0,1] neg_lo:[1,0,0] neg_hi:[1,0,0]
    v_pk_fma_f32 v[72:73], v[46:47], v[60:61], v[72:73] op_sel:[1,1,0] op_sel_hi:[1,0,1] neg_lo:[1,0,0]
    v_pk_fma_f32 v[68:69], v[46:47], v[58:59], v[68:69] op_sel:[1,1,0] op_sel_hi:[1,0,1] neg_lo:[1,0,0]
    v_pk_fma_f32 v[66:67], v[46:47], v[48:49], v[66:67] op_sel:[1,1,0] op_sel_hi:[1,0,1] neg_lo:[1,0,0]
    v_pk_mul_f32 v[108:109], v[72:73], v[60:61] op_sel_hi:[0,1]
    v_pk_mul_f32 v[116:117], v[114:115], v[114:115] op_sel_hi:[0,1]
    v_pk_mul_f32 v[82:83], v[72:73], v[50:51] op_sel_hi:[0,1]
    v_pk_mul_f32 v[70:71], v[66:67], v[58:59] op_sel_hi:[0,1]
    v_pk_mul_f32 v[74:75], v[66:67], v[60:61] op_sel_hi:[0,1]
    v_pk_mul_f32 v[76:77], v[68:69], v[60:61] op_sel_hi:[0,1]
    v_pk_mul_f32 v[80:81], v[68:69], v[50:51] op_sel_hi:[0,1]
    v_pk_fma_f32 v[108:109], v[72:73], v[60:61], v[108:109] op_sel:[1,1,0] op_sel_hi:[1,0,1] neg_lo:[1,0,0]
    v_pk_fma_f32 v[116:117], v[114:115], v[114:115], v[116:117] op_sel:[1,1,0] op_sel_hi:[1,0,1] neg_lo:[1,0,0]
    v_pk_fma_f32 v[82:83], v[72:73], v[50:51], v[82:83] op_sel:[1,1,0] op_sel_hi:[1,0,1] neg_lo:[1,0,0]
    v_pk_fma_f32 v[70:71], v[66:67], v[58:59], v[70:71] op_sel:[1,1,0] op_sel_hi:[1,0,1] neg_lo:[1,0,0]
    v_pk_fma_f32 v[74:75], v[66:67], v[60:61], v[74:75] op_sel:[1,1,0] op_sel_hi:[1,0,1] neg_lo:[1,0,0]
    v_pk_fma_f32 v[76:77], v[68:69], v[60:61], v[76:77] op_sel:[1,1,0] op_sel_hi:[1,0,1] neg_lo:[1,0,0]
    v_pk_fma_f32 v[80:81], v[68:69], v[50:51], v[80:81] op_sel:[1,1,0] op_sel_hi:[1,0,1] neg_lo:[1,0,0]
    v_pk_mul_f32 v[90:91], v[108:109], v[50:51] op_sel_hi:[0,1]
    v_pk_mul_f32 v[120:121], v[116:117], v[116:117] op_sel_hi:[0,1]
    v_pk_mul_f32 v[118:119], v[116:117], v[114:115] op_sel_hi:[0,1]
    v_pk_mul_f32 v[84:85], v[82:83], v[50:51] op_sel_hi:[0,1]
    v_pk_mul_f32 v[78:79], v[70:71], v[60:61] op_sel_hi:[0,1]
    v_pk_mul_f32 v[88:89], v[76:77], v[50:51] op_sel_hi:[0,1]
    v_pk_fma_f32 v[90:91], v[108:109], v[50:51], v[90:91] op_sel:[1,1,0] op_sel_hi:[1,0,1] neg_lo:[1,0,0]
    v_pk_fma_f32 v[120:121], v[116:117], v[116:117], v[120:121] op_sel:[1,1,0] op_sel_hi:[1,0,1] neg_lo:[1,0,0]
    v_pk_fma_f32 v[118:119], v[116:117], v[114:115], v[118:119] op_sel:[1,1,0] op_sel_hi:[1,0,1] neg_lo:[1,0,0]
    v_pk_fma_f32 v[84:85], v[82:83], v[50:51], v[84:85] op_sel:[1,1,0] op_sel_hi:[1,0,1] neg_lo:[1,0,0]
    v_pk_fma_f32 v[78:79], v[70:71], v[60:61], v[78:79] op_sel:[1,1,0] op_sel_hi:[1,0,1] neg_lo:[1,0,0]
    v_pk_fma_f32 v[88:89], v[76:77], v[50:51], v[88:89] op_sel:[1,1,0] op_sel_hi:[1,0,1] neg_lo:[1,0,0]
    v_pk_mul_f32 v[86:87], v[90:91], v[50:51] op_sel_hi:[0,1]
    v_pk_mul_f32 v[128:129], v[120:121], v[120:121] op_sel_hi:[0,1]
    v_pk_mul_f32 v[92:93], v[84:85], v[50:51] op_sel_hi:[0,1]
    v_pk_mul_f32 v[122:123], v[120:121], v[114:115] op_sel_hi:[0,1]
    v_pk_mul_f32 v[124:125], v[120:121], v[116:117] op_sel_hi:[0,1]
    v_pk_mul_f32 v[126:127], v[120:121], v[118:119] op_sel_hi:[0,1]
    v_pk_fma_f32 v[86:87], v[90:91], v[50:51], v[86:87] op_sel:[1,1,0] op_sel_hi:[1,0,1] neg_lo:[1,0,0]
    v_pk_fma_f32 v[128:129], v[120:121], v[120:121], v[128:129] op_sel:[1,1,0] op_sel_hi:[1,0,1] neg_lo:[1,0,0]
    v_pk_fma_f32 v[92:93], v[84:85], v[50:51], v[92:93] op_sel:[1,1,0] op_sel_hi:[1,0,1] neg_lo:[1,0,0]
    v_pk_fma_f32 v[122:123], v[120:121], v[114:115], v[122:123] op_sel:[1,1,0] op_sel_hi:[1,0,1] neg_lo:[1,0,0]
    v_pk_fma_f32 v[124:125], v[120:121], v[116:117], v[124:125] op_sel:[1,1,0] op_sel_hi:[1,0,1] neg_lo:[1,0,0]
    v_pk_fma_f32 v[126:127], v[120:121], v[118:119], v[126:127] op_sel:[1,1,0] op_sel_hi:[1,0,1] neg_lo:[1,0,0]
    v_pk_mul_f32 v[94:95], v[86:87], v[50:51] op_sel_hi:[0,1]
    v_pk_mul_f32 v[144:145], v[128:129], v[128:129] op_sel_hi:[0,1]
    v_pk_mul_f32 v[130:131], v[128:129], v[114:115] op_sel_hi:[0,1]
    v_pk_mul_f32 v[132:133], v[128:129], v[116:117] op_sel_hi:[0,1]
    v_pk_mul_f32 v[134:135], v[128:129], v[118:119] op_sel_hi:[0,1]
    v_pk_mul_f32 v[136:137], v[128:129], v[120:121] op_sel_hi:[0,1]
    v_pk_mul_f32 v[138:139], v[128:129], v[122:123] op_sel_hi:[0,1]
    v_pk_fma_f32 v[94:95], v[86:87], v[50:51], v[94:95] op_sel:[1,1,0] op_sel_hi:[1,0,1] neg_lo:[1,0,0]
    v_pk_fma_f32 v[144:145], v[128:129], v[128:129], v[144:145] op_sel:[1,1,0] op_sel_hi:[1,0,1] neg_lo:[1,0,0]
    v_pk_fma_f32 v[130:131], v[128:129], v[114:115], v[130:131] op_sel:[1,1,0] op_sel_hi:[1,0,1] neg_lo:[1,0,0]
    v_pk_fma_f32 v[132:133], v[128:129], v[116:117], v[132:133] op_sel:[1,1,0] op_sel_hi:[1,0,1] neg_lo:[1,0,0]
    v_pk_fma_f32 v[134:135], v[128:129], v[118:119], v[134:135] op_sel:[1,1,0] op_sel_hi:[1,0,1] neg_lo:[1,0,0]
    v_pk_fma_f32 v[136:137], v[128:129], v[120:121], v[136:137] op_sel:[1,1,0] op_sel_hi:[1,0,1] neg_lo:[1,0,0]
    v_pk_fma_f32 v[138:139], v[128:129], v[122:123], v[138:139] op_sel:[1,1,0] op_sel_hi:[1,0,1] neg_lo:[1,0,0]
    v_pk_mul_f32 v[96:97], v[94:95], v[50:51] op_sel_hi:[0,1]
    v_pk_mul_f32 v[140:141], v[128:129], v[124:125] op_sel_hi:[0,1]
    v_pk_mul_f32 v[142:143], v[128:129], v[126:127] op_sel_hi:[0,1]
    v_pk_mul_f32 v[146:147], v[144:145], v[114:115] op_sel_hi:[0,1]
    v_pk_mul_f32 v[148:149], v[144:145], v[116:117] op_sel_hi:[0,1]
    v_pk_mul_f32 v[150:151], v[144:145], v[118:119] op_sel_hi:[0,1]
    v_pk_fma_f32 v[96:97], v[94:95], v[50:51], v[96:97] op_sel:[1,1,0] op_sel_hi:[1,0,1] neg_lo:[1,0,0]
    v_pk_fma_f32 v[140:141], v[128:129], v[124:125], v[140:141] op_sel:[1,1,0] op_sel_hi:[1,0,1] neg_lo:[1,0,0]
    v_pk_fma_f32 v[142:143], v[128:129], v[126:127], v[142:143] op_sel:[1,1,0] op_sel_hi:[1,0,1] neg_lo:[1,0,0]
    v_pk_fma_f32 v[146:147], v[144:145], v[114:115], v[146:147] op_sel:[1,1,0] op_sel_hi:[1,0,1] neg_lo:[1,0,0]
    v_pk_fma_f32 v[148:149], v[144:145], v[116:117], v[148:149] op_sel:[1,1,0] op_sel_hi:[1,0,1] neg_lo:[1,0,0]
    v_pk_fma_f32 v[150:151], v[144:145], v[118:119], v[150:151] op_sel:[1,1,0] op_sel_hi:[1,0,1] neg_lo:[1,0,0]
    v_pk_mul_f32 v[104:105], v[96:97], v[50:51] op_sel_hi:[0,1]
    v_pk_mul_f32 v[152:153], v[144:145], v[120:121] op_sel_hi:[0,1]
    v_pk_mul_f32 v[154:155], v[144:145], v[122:123] op_sel_hi:[0,1]
    v_pk_mul_f32 v[156:157], v[144:145], v[124:125] op_sel_hi:[0,1]
    v_pk_mul_f32 v[158:159], v[144:145], v[126:127] op_sel_hi:[0,1]
    v_pk_fma_f32 v[104:105], v[96:97], v[50:51], v[104:105] op_sel:[1,1,0] op_sel_hi:[1,0,1] neg_lo:[1,0,0]
    v_pk_fma_f32 v[152:153], v[144:145], v[120:121], v[152:153] op_sel:[1,1,0] op_sel_hi:[1,0,1] neg_lo:[1,0,0]
    v_pk_fma_f32 v[154:155], v[144:145], v[122:123], v[154:155] op_sel:[1,1,0] op_sel_hi:[1,0,1] neg_lo:[1,0,0]
    v_pk_fma_f32 v[156:157], v[144:145], v[124:125], v[156:157] op_sel:[1,1,0] op_sel_hi:[1,0,1] neg_lo:[1,0,0]
    v_pk_fma_f32 v[158:159], v[144:145], v[126:127], v[158:159] op_sel:[1,1,0] op_sel_hi:[1,0,1] neg_lo:[1,0,0]
    v_pk_mul_f32 v[98:99], v[104:105], v[50:51] op_sel_hi:[0,1]
    v_pk_mul_f32 v[160:161], v[144:145], v[128:129] op_sel_hi:[0,1]
    v_pk_mul_f32 v[162:163], v[144:145], v[130:131] op_sel_hi:[0,1]
    v_pk_mul_f32 v[164:165], v[144:145], v[132:133] op_sel_hi:[0,1]
    v_pk_mul_f32 v[166:167], v[144:145], v[134:135] op_sel_hi:[0,1]
    v_pk_fma_f32 v[98:99], v[104:105], v[50:51], v[98:99] op_sel:[1,1,0] op_sel_hi:[1,0,1] neg_lo:[1,0,0]
    v_pk_fma_f32 v[160:161], v[144:145], v[128:129], v[160:161] op_sel:[1,1,0] op_sel_hi:[1,0,1] neg_lo:[1,0,0]
    v_pk_fma_f32 v[162:163], v[144:145], v[130:131], v[162:163] op_sel:[1,1,0] op_sel_hi:[1,0,1] neg_lo:[1,0,0]
    v_pk_fma_f32 v[164:165], v[144:145], v[132:133], v[164:165] op_sel:[1,1,0] op_sel_hi:[1,0,1] neg_lo:[1,0,0]
    v_pk_fma_f32 v[166:167], v[144:145], v[134:135], v[166:167] op_sel:[1,1,0] op_sel_hi:[1,0,1] neg_lo:[1,0,0]
    v_pk_mul_f32 v[106:107], v[98:99], v[50:51] op_sel_hi:[0,1]
    v_pk_mul_f32 v[168:169], v[144:145], v[136:137] op_sel_hi:[0,1]
    v_pk_mul_f32 v[170:171], v[144:145], v[138:139] op_sel_hi:[0,1]
    v_pk_mul_f32 v[172:173], v[144:145], v[140:141] op_sel_hi:[0,1]
    v_pk_mul_f32 v[174:175], v[144:145], v[142:143] op_sel_hi:[0,1]
    v_pk_fma_f32 v[106:107], v[98:99], v[50:51], v[106:107] op_sel:[1,1,0] op_sel_hi:[1,0,1] neg_lo:[1,0,0]
    v_pk_fma_f32 v[168:169], v[144:145], v[136:137], v[168:169] op_sel:[1,1,0] op_sel_hi:[1,0,1] neg_lo:[1,0,0]
    v_pk_fma_f32 v[170:171], v[144:145], v[138:139], v[170:171] op_sel:[1,1,0] op_sel_hi:[1,0,1] neg_lo:[1,0,0]
    v_pk_fma_f32 v[172:173], v[144:145], v[140:141], v[172:173] op_sel:[1,1,0] op_sel_hi:[1,0,1] neg_lo:[1,0,0]
    v_pk_fma_f32 v[174:175], v[144:145], v[142:143], v[174:175] op_sel:[1,1,0] op_sel_hi:[1,0,1] neg_lo:[1,0,0]
    s_waitcnt lgkmcnt(0)
    v_mfma_f32_32x32x16_bf16 v[232:247], v[192:195], v[196:199], 0
    v_cvt_pk_bf16_f32 v176, v46, v47
    v_cvt_pk_bf16_f32 v66, v66, v67
    v_cvt_pk_bf16_f32 v68, v68, v69
    v_cvt_pk_bf16_f32 v70, v70, v71
    v_cvt_pk_bf16_f32 v72, v72, v73
    v_cvt_pk_bf16_f32 v74, v74, v75
    v_mfma_f32_32x32x16_bf16 v[232:247], v[200:203], v[204:207], v[232:247]
    v_cvt_pk_bf16_f32 v76, v76, v77
    v_cvt_pk_bf16_f32 v78, v78, v79
    v_cvt_pk_bf16_f32 v80, v80, v81
    v_cvt_pk_bf16_f32 v82, v82, v83
    v_cvt_pk_bf16_f32 v84, v84, v85
    v_cvt_pk_bf16_f32 v86, v86, v87
    v_cvt_pk_bf16_f32 v88, v88, v89
    v_pk_mul_f32 v[58:59], v[54:55], v[54:55] op_sel_hi:[0,1]
    s_mov_b32 m0, s81
    s_nop 0
    ds_write_addtid_b32 v176 offset:0
    ds_write_addtid_b32 v66 offset:272
    ds_write_addtid_b32 v68 offset:544
    ds_write_addtid_b32 v70 offset:816
    ds_write_addtid_b32 v72 offset:1088
    ds_write_addtid_b32 v74 offset:1360
    v_mfma_f32_32x32x16_bf16 v[232:247], v[208:211], v[212:215], v[232:247]
    v_cvt_pk_bf16_f32 v90, v90, v91
    v_cvt_pk_bf16_f32 v92, v92, v93
    v_cvt_pk_bf16_f32 v94, v94, v95
    v_cvt_pk_bf16_f32 v96, v96, v97
    v_cvt_pk_bf16_f32 v98, v98, v99
    v_cvt_pk_bf16_f32 v104, v104, v105
    ds_write_addtid_b32 v76 offset:1632
    ds_write_addtid_b32 v78 offset:1904
    ds_write_addtid_b32 v80 offset:2176
    ds_write_addtid_b32 v82 offset:2448
    ds_write_addtid_b32 v84 offset:2720
    ds_write_addtid_b32 v86 offset:2992
    ds_write_addtid_b32 v88 offset:3264
    v_mfma_f32_32x32x16_bf16 v[232:247], v[216:219], v[220:223], v[232:247]
    v_cvt_pk_bf16_f32 v106, v106, v107
    v_cvt_pk_bf16_f32 v108, v108, v109
    v_cvt_pk_bf16_f32 v114, v114, v115
    v_cvt_pk_bf16_f32 v116, v116, v117
    v_cvt_pk_bf16_f32 v118, v118, v119
    v_cvt_pk_bf16_f32 v120, v120, v121
    v_cvt_pk_bf16_f32 v122, v122, v123
    v_pk_fma_f32 v[58:59], v[54:55], v[54:55], v[58:59] op_sel:[1,1,0] op_sel_hi:[1,0,1] neg_lo:[1,0,0]
    ds_write_addtid_b32 v90 offset:3536
    ds_write_addtid_b32 v92 offset:3808
    ds_write_addtid_b32 v94 offset:4080
    ds_write_addtid_b32 v96 offset:4352
    ds_write_addtid_b32 v98 offset:4624
    ds_write_addtid_b32 v104 offset:5440
    v_mfma_f32_32x32x16_bf16 v[232:247], v[224:227], v[228:231], v[232:247]
    v_cvt_pk_bf16_f32 v124, v124, v125
    v_cvt_pk_bf16_f32 v126, v126, v127
    v_cvt_pk_bf16_f32 v128, v128, v129
    v_cvt_pk_bf16_f32 v130, v130, v131
    v_cvt_pk_bf16_f32 v132, v132, v133
    v_cvt_pk_bf16_f32 v134, v134, v135
    ds_write_addtid_b32 v106 offset:5712
    ds_write_addtid_b32 v108 offset:5984
    s_mov_b32 m0, s82
    s_nop 0
    ds_write_addtid_b32 v114 offset:50320
    ds_write_addtid_b32 v116 offset:50592
    ds_write_addtid_b32 v118 offset:50864
    ds_write_addtid_b32 v120 offset:51136
    ds_write_addtid_b32 v122 offset:51408
    v_mfma_f32_32x32x16_bf16 v[232:247], v[24:27], v[28:31], v[232:247]
    v_cvt_pk_bf16_f32 v136, v136, v137
    v_cvt_pk_bf16_f32 v138, v138, v139
    v_cvt_pk_bf16_f32 v140, v140, v141
    v_cvt_pk_bf16_f32 v142, v142, v143
    v_cvt_pk_bf16_f32 v144, v144, v145
    v_cvt_pk_bf16_f32 v146, v146, v147
    v_cvt_pk_bf16_f32 v148, v148, v149
    v_pk_mul_f32 v[60:61], v[58:59], v[58:59] op_sel_hi:[0,1]
    ds_write_addtid_b32 v124 offset:51680
    ds_write_addtid_b32 v126 offset:51952
    ds_write_addtid_b32 v128 offset:52224
    ds_write_addtid_b32 v130 offset:52496
    ds_write_addtid_b32 v132 offset:52768
    ds_write_addtid_b32 v134 offset:53040
    v_mfma_f32_32x32x16_bf16 v[232:247], v[32:35], v[36:39], v[232:247]
    v_cvt_pk_bf16_f32 v150, v150, v151
    v_cvt_pk_bf16_f32 v152, v152, v153
    v_cvt_pk_bf16_f32 v154, v154, v155
    v_cvt_pk_bf16_f32 v156, v156, v157
    v_cvt_pk_bf16_f32 v158, v158, v159
    v_cvt_pk_bf16_f32 v160, v160, v161
    ds_write_addtid_b32 v136 offset:53312
    ds_write_addtid_b32 v138 offset:53584
    ds_write_addtid_b32 v140 offset:53856
    ds_write_addtid_b32 v142 offset:54128
    ds_write_addtid_b32 v144 offset:54400
    ds_write_addtid_b32 v146 offset:54672
    ds_write_addtid_b32 v148 offset:54944
    v_mfma_f32_32x32x16_bf16 v[232:247], v[8:11], v[12:15], v[232:247]
    v_cvt_pk_bf16_f32 v162, v162, v163
    v_cvt_pk_bf16_f32 v164, v164, v165
    v_cvt_pk_bf16_f32 v166, v166, v167
    v_cvt_pk_bf16_f32 v168, v168, v169
    v_cvt_pk_bf16_f32 v170, v170, v171
    v_cvt_pk_bf16_f32 v172, v172, v173
    v_cvt_pk_bf16_f32 v174, v174, v175
    v_pk_fma_f32 v[60:61], v[58:59], v[58:59], v[60:61] op_sel:[1,1,0] op_sel_hi:[1,0,1] neg_lo:[1,0,0]
    ds_write_addtid_b32 v150 offset:55216
    ds_write_addtid_b32 v152 offset:55488
    ds_write_addtid_b32 v154 offset:55760
    ds_write_addtid_b32 v156 offset:56032
    ds_write_addtid_b32 v158 offset:56304
    ds_write_addtid_b32 v160 offset:56576
    ds_write_addtid_b32 v162 offset:56848
    ds_write_addtid_b32 v164 offset:57120
    ds_write_addtid_b32 v166 offset:57392
    ds_write_addtid_b32 v168 offset:57664
    ds_write_addtid_b32 v170 offset:57936
    ds_write_addtid_b32 v172 offset:58208
    ds_write_addtid_b32 v174 offset:58480
    ds_read_b128 v[192:195], v3 offset:0
    ds_read_b128 v[196:199], v2 offset:0
    ds_read_b128 v[200:203], v3 offset:32
    ds_read_b128 v[204:207], v2 offset:32
    ds_read_b128 v[208:211], v3 offset:64
    ds_read_b128 v[212:215], v2 offset:64
    ds_read_b128 v[216:219], v3 offset:96
    ds_read_b128 v[220:223], v2 offset:96
    ds_read_b128 v[224:227], v3 offset:128
    ds_read_b128 v[228:231], v2 offset:128
    ds_read_b128 v[24:27], v3 offset:160
    ds_read_b128 v[28:31], v2 offset:160
    ds_read_b128 v[32:35], v3 offset:192
    ds_read_b128 v[36:39], v2 offset:192
    ds_read_b128 v[8:11], v3 offset:224
    ds_read_b128 v[12:15], v2 offset:224
    v_pk_mul_f32 v[114:115], v[60:61], v[60:61] op_sel_hi:[0,1] neg_hi:[1,0]
    v_pk_mul_f32 v[72:73], v[52:53], v[60:61] op_sel_hi:[0,1]
    v_pk_mul_f32 v[68:69], v[52:53], v[58:59] op_sel_hi:[0,1]
    v_pk_mul_f32 v[66:67], v[52:53], v[54:55] op_sel_hi:[0,1]
    v_pk_fma_f32 v[114:115], v[60:61], v[60:61], v[114:115] op_sel:[1,1,0] op_sel_hi:[1,0,1] neg_lo:[1,0,0] neg_hi:[1,0,0]
    v_pk_fma_f32 v[72:73], v[52:53], v[60:61], v[72:73] op_sel:[1,1,0] op_sel_hi:[1,0,1] neg_lo:[1,0,0]
    v_pk_fma_f32 v[68:69], v[52:53], v[58:59], v[68:69] op_sel:[1,1,0] op_sel_hi:[1,0,1] neg_lo:[1,0,0]
    v_pk_fma_f32 v[66:67], v[52:53], v[54:55], v[66:67] op_sel:[1,1,0] op_sel_hi:[1,0,1] neg_lo:[1,0,0]
    v_pk_mul_f32 v[108:109], v[72:73], v[60:61] op_sel_hi:[0,1]
    v_pk_mul_f32 v[116:117], v[114:115], v[114:115] op_sel_hi:[0,1]
    v_pk_mul_f32 v[82:83], v[72:73], v[56:57] op_sel_hi:[0,1]
    v_pk_mul_f32 v[70:71], v[66:67], v[58:59] op_sel_hi:[0,1]
    v_pk_mul_f32 v[74:75], v[66:67], v[60:61] op_sel_hi:[0,1]
    v_pk_mul_f32 v[76:77], v[68:69], v[60:61] op_sel_hi:[0,1]
    v_pk_mul_f32 v[80:81], v[68:69], v[56:57] op_sel_hi:[0,1]
    v_pk_fma_f32 v[108:109], v[72:73], v[60:61], v[108:109] op_sel:[1,1,0] op_sel_hi:[1,0,1] neg_lo:[1,0,0]
    v_pk_fma_f32 v[116:117], v[114:115], v[114:115], v[116:117] op_sel:[1,1,0] op_sel_hi:[1,0,1] neg_lo:[1,0,0]
    v_pk_fma_f32 v[82:83], v[72:73], v[56:57], v[82:83] op_sel:[1,1,0] op_sel_hi:[1,0,1] neg_lo:[1,0,0]
    v_pk_fma_f32 v[70:71], v[66:67], v[58:59], v[70:71] op_sel:[1,1,0] op_sel_hi:[1,0,1] neg_lo:[1,0,0]
    v_pk_fma_f32 v[74:75], v[66:67], v[60:61], v[74:75] op_sel:[1,1,0] op_sel_hi:[1,0,1] neg_lo:[1,0,0]
    v_pk_fma_f32 v[76:77], v[68:69], v[60:61], v[76:77] op_sel:[1,1,0] op_sel_hi:[1,0,1] neg_lo:[1,0,0]
    v_pk_fma_f32 v[80:81], v[68:69], v[56:57], v[80:81] op_sel:[1,1,0] op_sel_hi:[1,0,1] neg_lo:[1,0,0]
    v_pk_mul_f32 v[90:91], v[108:109], v[56:57] op_sel_hi:[0,1]
    v_pk_mul_f32 v[120:121], v[116:117], v[116:117] op_sel_hi:[0,1]
    v_pk_mul_f32 v[118:119], v[116:117], v[114:115] op_sel_hi:[0,1]
    v_pk_mul_f32 v[84:85], v[82:83], v[56:57] op_sel_hi:[0,1]
    v_pk_mul_f32 v[78:79], v[70:71], v[60:61] op_sel_hi:[0,1]
    v_pk_mul_f32 v[88:89], v[76:77], v[56:57] op_sel_hi:[0,1]
    v_pk_fma_f32 v[90:91], v[108:109], v[56:57], v[90:91] op_sel:[1,1,0] op_sel_hi:[1,0,1] neg_lo:[1,0,0]
    v_pk_fma_f32 v[120:121], v[116:117], v[116:117], v[120:121] op_sel:[1,1,0] op_sel_hi:[1,0,1] neg_lo:[1,0,0]
    v_pk_fma_f32 v[118:119], v[116:117], v[114:115], v[118:119] op_sel:[1,1,0] op_sel_hi:[1,0,1] neg_lo:[1,0,0]
    v_pk_fma_f32 v[84:85], v[82:83], v[56:57], v[84:85] op_sel:[1,1,0] op_sel_hi:[1,0,1] neg_lo:[1,0,0]
    v_pk_fma_f32 v[78:79], v[70:71], v[60:61], v[78:79] op_sel:[1,1,0] op_sel_hi:[1,0,1] neg_lo:[1,0,0]
    v_pk_fma_f32 v[88:89], v[76:77], v[56:57], v[88:89] op_sel:[1,1,0] op_sel_hi:[1,0,1] neg_lo:[1,0,0]
    v_pk_mul_f32 v[86:87], v[90:91], v[56:57] op_sel_hi:[0,1]
    v_pk_mul_f32 v[128:129], v[120:121], v[120:121] op_sel_hi:[0,1]
    v_pk_mul_f32 v[92:93], v[84:85], v[56:57] op_sel_hi:[0,1]
    v_pk_mul_f32 v[122:123], v[120:121], v[114:115] op_sel_hi:[0,1]
    v_pk_mul_f32 v[124:125], v[120:121], v[116:117] op_sel_hi:[0,1]
    v_pk_mul_f32 v[126:127], v[120:121], v[118:119] op_sel_hi:[0,1]
    v_pk_fma_f32 v[86:87], v[90:91], v[56:57], v[86:87] op_sel:[1,1,0] op_sel_hi:[1,0,1] neg_lo:[1,0,0]
    v_pk_fma_f32 v[128:129], v[120:121], v[120:121], v[128:129] op_sel:[1,1,0] op_sel_hi:[1,0,1] neg_lo:[1,0,0]
    v_pk_fma_f32 v[92:93], v[84:85], v[56:57], v[92:93] op_sel:[1,1,0] op_sel_hi:[1,0,1] neg_lo:[1,0,0]
    v_pk_fma_f32 v[122:123], v[120:121], v[114:115], v[122:123] op_sel:[1,1,0] op_sel_hi:[1,0,1] neg_lo:[1,0,0]
    v_pk_fma_f32 v[124:125], v[120:121], v[116:117], v[124:125] op_sel:[1,1,0] op_sel_hi:[1,0,1] neg_lo:[1,0,0]
    v_pk_fma_f32 v[126:127], v[120:121], v[118:119], v[126:127] op_sel:[1,1,0] op_sel_hi:[1,0,1] neg_lo:[1,0,0]
    v_pk_mul_f32 v[94:95], v[86:87], v[56:57] op_sel_hi:[0,1]
    v_pk_mul_f32 v[144:145], v[128:129], v[128:129] op_sel_hi:[0,1]
    v_pk_mul_f32 v[130:131], v[128:129], v[114:115] op_sel_hi:[0,1]
    v_pk_mul_f32 v[132:133], v[128:129], v[116:117] op_sel_hi:[0,1]
    v_pk_mul_f32 v[134:135], v[128:129], v[118:119] op_sel_hi:[0,1]
    v_pk_mul_f32 v[136:137], v[128:129], v[120:121] op_sel_hi:[0,1]
    v_pk_mul_f32 v[138:139], v[128:129], v[122:123] op_sel_hi:[0,1]
    v_pk_fma_f32 v[94:95], v[86:87], v[56:57], v[94:95] op_sel:[1,1,0] op_sel_hi:[1,0,1] neg_lo:[1,0,0]
    v_pk_fma_f32 v[144:145], v[128:129], v[128:129], v[144:145] op_sel:[1,1,0] op_sel_hi:[1,0,1] neg_lo:[1,0,0]
    v_pk_fma_f32 v[130:131], v[128:129], v[114:115], v[130:131] op_sel:[1,1,0] op_sel_hi:[1,0,1] neg_lo:[1,0,0]
    v_pk_fma_f32 v[132:133], v[128:129], v[116:117], v[132:133] op_sel:[1,1,0] op_sel_hi:[1,0,1] neg_lo:[1,0,0]
    v_pk_fma_f32 v[134:135], v[128:129], v[118:119], v[134:135] op_sel:[1,1,0] op_sel_hi:[1,0,1] neg_lo:[1,0,0]
    v_pk_fma_f32 v[136:137], v[128:129], v[120:121], v[136:137] op_sel:[1,1,0] op_sel_hi:[1,0,1] neg_lo:[1,0,0]
    v_pk_fma_f32 v[138:139], v[128:129], v[122:123], v[138:139] op_sel:[1,1,0] op_sel_hi:[1,0,1] neg_lo:[1,0,0]
    v_pk_mul_f32 v[96:97], v[94:95], v[56:57] op_sel_hi:[0,1]
    v_pk_mul_f32 v[140:141], v[128:129], v[124:125] op_sel_hi:[0,1]
    v_pk_mul_f32 v[142:143], v[128:129], v[126:127] op_sel_hi:[0,1]
    v_pk_mul_f32 v[146:147], v[144:145], v[114:115] op_sel_hi:[0,1]
    v_pk_mul_f32 v[148:149], v[144:145], v[116:117] op_sel_hi:[0,1]
    v_pk_mul_f32 v[150:151], v[144:145], v[118:119] op_sel_hi:[0,1]
    v_pk_fma_f32 v[96:97], v[94:95], v[56:57], v[96:97] op_sel:[1,1,0] op_sel_hi:[1,0,1] neg_lo:[1,0,0]
    v_pk_fma_f32 v[140:141], v[128:129], v[124:125], v[140:141] op_sel:[1,1,0] op_sel_hi:[1,0,1] neg_lo:[1,0,0]
    v_pk_fma_f32 v[142:143], v[128:129], v[126:127], v[142:143] op_sel:[1,1,0] op_sel_hi:[1,0,1] neg_lo:[1,0,0]
    v_pk_fma_f32 v[146:147], v[144:145], v[114:115], v[146:147] op_sel:[1,1,0] op_sel_hi:[1,0,1] neg_lo:[1,0,0]
    v_pk_fma_f32 v[148:149], v[144:145], v[116:117], v[148:149] op_sel:[1,1,0] op_sel_hi:[1,0,1] neg_lo:[1,0,0]
    v_pk_fma_f32 v[150:151], v[144:145], v[118:119], v[150:151] op_sel:[1,1,0] op_sel_hi:[1,0,1] neg_lo:[1,0,0]
    v_pk_mul_f32 v[104:105], v[96:97], v[56:57] op_sel_hi:[0,1]
    v_pk_mul_f32 v[152:153], v[144:145], v[120:121] op_sel_hi:[0,1]
    v_pk_mul_f32 v[154:155], v[144:145], v[122:123] op_sel_hi:[0,1]
    v_pk_mul_f32 v[156:157], v[144:145], v[124:125] op_sel_hi:[0,1]
    v_pk_mul_f32 v[158:159], v[144:145], v[126:127] op_sel_hi:[0,1]
    v_pk_fma_f32 v[104:105], v[96:97], v[56:57], v[104:105] op_sel:[1,1,0] op_sel_hi:[1,0,1] neg_lo:[1,0,0]
    v_pk_fma_f32 v[152:153], v[144:145], v[120:121], v[152:153] op_sel:[1,1,0] op_sel_hi:[1,0,1] neg_lo:[1,0,0]
    v_pk_fma_f32 v[154:155], v[144:145], v[122:123], v[154:155] op_sel:[1,1,0] op_sel_hi:[1,0,1] neg_lo:[1,0,0]
    v_pk_fma_f32 v[156:157], v[144:145], v[124:125], v[156:157] op_sel:[1,1,0] op_sel_hi:[1,0,1] neg_lo:[1,0,0]
    v_pk_fma_f32 v[158:159], v[144:145], v[126:127], v[158:159] op_sel:[1,1,0] op_sel_hi:[1,0,1] neg_lo:[1,0,0]
    v_pk_mul_f32 v[98:99], v[104:105], v[56:57] op_sel_hi:[0,1]
    v_pk_mul_f32 v[160:161], v[144:145], v[128:129] op_sel_hi:[0,1]
    v_pk_mul_f32 v[162:163], v[144:145], v[130:131] op_sel_hi:[0,1]
    v_pk_mul_f32 v[164:165], v[144:145], v[132:133] op_sel_hi:[0,1]
    v_pk_mul_f32 v[166:167], v[144:145], v[134:135] op_sel_hi:[0,1]
    v_pk_fma_f32 v[98:99], v[104:105], v[56:57], v[98:99] op_sel:[1,1,0] op_sel_hi:[1,0,1] neg_lo:[1,0,0]
    v_pk_fma_f32 v[160:161], v[144:145], v[128:129], v[160:161] op_sel:[1,1,0] op_sel_hi:[1,0,1] neg_lo:[1,0,0]
    v_pk_fma_f32 v[162:163], v[144:145], v[130:131], v[162:163] op_sel:[1,1,0] op_sel_hi:[1,0,1] neg_lo:[1,0,0]
    v_pk_fma_f32 v[164:165], v[144:145], v[132:133], v[164:165] op_sel:[1,1,0] op_sel_hi:[1,0,1] neg_lo:[1,0,0]
    v_pk_fma_f32 v[166:167], v[144:145], v[134:135], v[166:167] op_sel:[1,1,0] op_sel_hi:[1,0,1] neg_lo:[1,0,0]
    v_pk_mul_f32 v[106:107], v[98:99], v[56:57] op_sel_hi:[0,1]
    v_pk_mul_f32 v[168:169], v[144:145], v[136:137] op_sel_hi:[0,1]
    v_pk_mul_f32 v[170:171], v[144:145], v[138:139] op_sel_hi:[0,1]
    v_pk_mul_f32 v[172:173], v[144:145], v[140:141] op_sel_hi:[0,1]
    v_pk_mul_f32 v[174:175], v[144:145], v[142:143] op_sel_hi:[0,1]
    v_pk_fma_f32 v[106:107], v[98:99], v[56:57], v[106:107] op_sel:[1,1,0] op_sel_hi:[1,0,1] neg_lo:[1,0,0]
    v_pk_fma_f32 v[168:169], v[144:145], v[136:137], v[168:169] op_sel:[1,1,0] op_sel_hi:[1,0,1] neg_lo:[1,0,0]
    v_pk_fma_f32 v[170:171], v[144:145], v[138:139], v[170:171] op_sel:[1,1,0] op_sel_hi:[1,0,1] neg_lo:[1,0,0]
    v_pk_fma_f32 v[172:173], v[144:145], v[140:141], v[172:173] op_sel:[1,1,0] op_sel_hi:[1,0,1] neg_lo:[1,0,0]
    v_pk_fma_f32 v[174:175], v[144:145], v[142:143], v[174:175] op_sel:[1,1,0] op_sel_hi:[1,0,1] neg_lo:[1,0,0]
    s_waitcnt lgkmcnt(0)
    v_mfma_f32_32x32x16_bf16 v[232:247], v[192:195], v[196:199], v[232:247]
    v_cvt_pk_bf16_f32 v176, v52, v53
    v_cvt_pk_bf16_f32 v66, v66, v67
    v_cvt_pk_bf16_f32 v68, v68, v69
    v_cvt_pk_bf16_f32 v70, v70, v71
    v_cvt_pk_bf16_f32 v72, v72, v73
    v_cvt_pk_bf16_f32 v74, v74, v75
    v_mfma_f32_32x32x16_bf16 v[232:247], v[200:203], v[204:207], v[232:247]
    v_cvt_pk_bf16_f32 v76, v76, v77
    v_cvt_pk_bf16_f32 v78, v78, v79
    v_cvt_pk_bf16_f32 v80, v80, v81
    v_cvt_pk_bf16_f32 v82, v82, v83
    v_cvt_pk_bf16_f32 v84, v84, v85
    v_cvt_pk_bf16_f32 v86, v86, v87
    v_cvt_pk_bf16_f32 v88, v88, v89
    s_mov_b32 m0, s81
    s_nop 0
    ds_write_addtid_b32 v176 offset:0
    ds_write_addtid_b32 v66 offset:272
    ds_write_addtid_b32 v68 offset:544
    ds_write_addtid_b32 v70 offset:816
    ds_write_addtid_b32 v72 offset:1088
    ds_write_addtid_b32 v74 offset:1360
    v_mfma_f32_32x32x16_bf16 v[232:247], v[208:211], v[212:215], v[232:247]
    v_cvt_pk_bf16_f32 v90, v90, v91
    v_cvt_pk_bf16_f32 v92, v92, v93
    v_cvt_pk_bf16_f32 v94, v94, v95
    v_cvt_pk_bf16_f32 v96, v96, v97
    v_cvt_pk_bf16_f32 v98, v98, v99
    v_cvt_pk_bf16_f32 v104, v104, v105
    ds_write_addtid_b32 v76 offset:1632
    ds_write_addtid_b32 v78 offset:1904
    ds_write_addtid_b32 v80 offset:2176
    ds_write_addtid_b32 v82 offset:2448
    ds_write_addtid_b32 v84 offset:2720
    ds_write_addtid_b32 v86 offset:2992
    ds_write_addtid_b32 v88 offset:3264
    v_mfma_f32_32x32x16_bf16 v[232:247], v[216:219], v[220:223], v[232:247]
    v_cvt_pk_bf16_f32 v106, v106, v107
    v_cvt_pk_bf16_f32 v108, v108, v109
    v_cvt_pk_bf16_f32 v114, v114, v115
    v_cvt_pk_bf16_f32 v116, v116, v117
    v_cvt_pk_bf16_f32 v118, v118, v119
    v_cvt_pk_bf16_f32 v120, v120, v121
    v_cvt_pk_bf16_f32 v122, v122, v123
    ds_write_addtid_b32 v90 offset:3536
    ds_write_addtid_b32 v92 offset:3808
    ds_write_addtid_b32 v94 offset:4080
    ds_write_addtid_b32 v96 offset:4352
    ds_write_addtid_b32 v98 offset:4624
    ds_write_addtid_b32 v104 offset:5440
    v_mfma_f32_32x32x16_bf16 v[232:247], v[224:227], v[228:231], v[232:247]
    v_cvt_pk_bf16_f32 v124, v124, v125
    v_cvt_pk_bf16_f32 v126, v126, v127
    v_cvt_pk_bf16_f32 v128, v128, v129
    v_cvt_pk_bf16_f32 v130, v130, v131
    v_cvt_pk_bf16_f32 v132, v132, v133
    v_cvt_pk_bf16_f32 v134, v134, v135
    ds_write_addtid_b32 v106 offset:5712
    ds_write_addtid_b32 v108 offset:5984
    s_mov_b32 m0, s82
    s_nop 0
    ds_write_addtid_b32 v114 offset:50320
    ds_write_addtid_b32 v116 offset:50592
    ds_write_addtid_b32 v118 offset:50864
    ds_write_addtid_b32 v120 offset:51136
    ds_write_addtid_b32 v122 offset:51408
    v_mfma_f32_32x32x16_bf16 v[232:247], v[24:27], v[28:31], v[232:247]
    v_cvt_pk_bf16_f32 v136, v136, v137
    v_cvt_pk_bf16_f32 v138, v138, v139
    v_cvt_pk_bf16_f32 v140, v140, v141
    v_cvt_pk_bf16_f32 v142, v142, v143
    v_cvt_pk_bf16_f32 v144, v144, v145
    v_cvt_pk_bf16_f32 v146, v146, v147
    v_cvt_pk_bf16_f32 v148, v148, v149
    ds_write_addtid_b32 v124 offset:51680
    ds_write_addtid_b32 v126 offset:51952
    ds_write_addtid_b32 v128 offset:52224
    ds_write_addtid_b32 v130 offset:52496
    ds_write_addtid_b32 v132 offset:52768
    ds_write_addtid_b32 v134 offset:53040
    v_mfma_f32_32x32x16_bf16 v[232:247], v[32:35], v[36:39], v[232:247]
    v_cvt_pk_bf16_f32 v150, v150, v151
    v_cvt_pk_bf16_f32 v152, v152, v153
    v_cvt_pk_bf16_f32 v154, v154, v155
    v_cvt_pk_bf16_f32 v156, v156, v157
    v_cvt_pk_bf16_f32 v158, v158, v159
    v_cvt_pk_bf16_f32 v160, v160, v161
    ds_write_addtid_b32 v136 offset:53312
    ds_write_addtid_b32 v138 offset:53584
    ds_write_addtid_b32 v140 offset:53856
    ds_write_addtid_b32 v142 offset:54128
    ds_write_addtid_b32 v144 offset:54400
    ds_write_addtid_b32 v146 offset:54672
    ds_write_addtid_b32 v148 offset:54944
    v_mfma_f32_32x32x16_bf16 v[232:247], v[8:11], v[12:15], v[232:247]
    v_cvt_pk_bf16_f32 v162, v162, v163
    v_cvt_pk_bf16_f32 v164, v164, v165
    v_cvt_pk_bf16_f32 v166, v166, v167
    v_cvt_pk_bf16_f32 v168, v168, v169
    v_cvt_pk_bf16_f32 v170, v170, v171
    v_cvt_pk_bf16_f32 v172, v172, v173
    v_cvt_pk_bf16_f32 v174, v174, v175
    ds_write_addtid_b32 v150 offset:55216
    ds_write_addtid_b32 v152 offset:55488
    ds_write_addtid_b32 v154 offset:55760
    ds_write_addtid_b32 v156 offset:56032
    ds_write_addtid_b32 v158 offset:56304
    ds_write_addtid_b32 v160 offset:56576
    ds_write_addtid_b32 v162 offset:56848
    ds_write_addtid_b32 v164 offset:57120
    ds_write_addtid_b32 v166 offset:57392
    ds_write_addtid_b32 v168 offset:57664
    ds_write_addtid_b32 v170 offset:57936
    ds_write_addtid_b32 v172 offset:58208
    ds_write_addtid_b32 v174 offset:58480
    ds_read_b128 v[192:195], v3 offset:0
    ds_read_b128 v[196:199], v2 offset:0
    ds_read_b128 v[200:203], v3 offset:32
    ds_read_b128 v[204:207], v2 offset:32
    ds_read_b128 v[208:211], v3 offset:64
    ds_read_b128 v[212:215], v2 offset:64
    ds_read_b128 v[216:219], v3 offset:96
    ds_read_b128 v[220:223], v2 offset:96
    ds_read_b128 v[224:227], v3 offset:128
    ds_read_b128 v[228:231], v2 offset:128
    ds_read_b128 v[24:27], v3 offset:160
    ds_read_b128 v[28:31], v2 offset:160
    ds_read_b128 v[32:35], v3 offset:192
    ds_read_b128 v[36:39], v2 offset:192
    ds_read_b128 v[8:11], v3 offset:224
    ds_read_b128 v[12:15], v2 offset:224
    s_cmp_ge_u32 s3, 4
    s_cbranch_scc1 CVN_24
    v_add_u32 v4, 5120, v5
    global_load_dwordx4 v[128:131], v5, s[16:17] offset:0
    global_load_dwordx4 v[132:135], v5, s[16:17] offset:1280
    global_load_dwordx4 v[136:139], v5, s[16:17] offset:2560
    global_load_dwordx4 v[140:143], v5, s[16:17] offset:3840
    global_load_dwordx4 v[144:147], v4, s[16:17] offset:0
    global_load_dwordx4 v[148:151], v4, s[16:17] offset:1280
    global_load_dwordx4 v[152:155], v4, s[16:17] offset:2560
    global_load_dwordx4 v[156:159], v4, s[16:17] offset:3840
CVN_24:
    v_lshl_add_u32 v5, v1, 4, s11
    v_lshl_add_u32 v16, v1, 2, s11
    v_mov_b32 v22, 0
    v_mov_b32 v23, 0
    v_mov_b32 v20, 0
    v_lshlrev_b32 v17, 16, v21
    v_mov_b32 v21, 0
    s_waitcnt lgkmcnt(0)
    v_mfma_f32_32x32x16_bf16 v[232:247], v[192:195], v[196:199], v[232:247]
    ds_write_b128 v5, v[20:23] offset:1024
    ds_write_b128 v5, v[20:23] offset:2240
    ds_write_b32 v16, v20
    v_mfma_f32_32x32x16_bf16 v[232:247], v[200:203], v[204:207], v[232:247]
    v_and_b32 v4, 31, v1
    v_lshlrev_b32 v4, 4, v4
    v_lshrrev_b32 v18, 5, v1
    v_lshl_add_u32 v4, v18, 3, v4
    v_mfma_f32_32x32x16_bf16 v[232:247], v[208:211], v[212:215], v[232:247]
    v_add_u32 v4, s11, v4
    v_lshl_add_u32 v18, v1, 1, s11
    v_mov_b32 v19, s11
    v_cmp_eq_u32 vcc, 0, v1
    v_mfma_f32_32x32x16_bf16 v[232:247], v[216:219], v[220:223], v[232:247]
    s_nop 0
    v_cndmask_b32 v17, 0, v17, vcc
    v_and_b32 v64, 15, v1
    v_add_u32 v65, 10, v64
    v_lshrrev_b32 v65, 1, v65
    v_mfma_f32_32x32x16_bf16 v[232:247], v[224:227], v[228:231], v[232:247]
    v_lshrrev_b32 v66, 5, v1
    v_bfe_u32 v67, v1, 4, 1
    v_lshlrev_b32 v66, 1, v66
    v_sub_u32 v66, v66, v67
    v_mfma_f32_32x32x16_bf16 v[232:247], v[24:27], v[28:31], v[232:247]
    v_lshl_add_u32 v65, v66, 2, v65
    v_and_b32 v67, 1, v1
    v_xor_b32 v67, 1, v67
    s_movk_i32 s6, 304
    v_mfma_f32_32x32x16_bf16 v[232:247], v[32:35], v[36:39], v[232:247]
    v_mad_u32_u24 v65, v67, s6, v65
    v_lshl_add_u32 v2, v65, 2, s11
    v_add_u32 v3, 1024, v2
    v_lshl_add_u32 v65, v66, 3, v64
    v_mfma_f32_32x32x16_bf16 v[232:247], v[8:11], v[12:15], v[232:247]
    v_sub_u32 v6, 12, v65
    v_lshlrev_b32 v66, 4, v66
    v_lshlrev_b32 v67, 5, v64
    v_sub_u32 v66, v66, v67
    s_add_u32 s6, s10, 496
    v_add_u32 v7, s6, v66
    v_and_b32 v8, 48, v1
    v_lshl_add_u32 v9, v64, 4, v8
    s_add_u32 s6, s10, 1024
    v_add_u32 v9, s6, v9
    v_lshl_add_u32 v10, v64, 5, v8
    s_add_u32 s6, s10, 2056
    v_add_u32 v10, s6, v10
    v_lshl_add_u32 v11, v64, 3, v8
    v_add_u32 v11, s11, v11
    v_lshl_add_u32 v12, v64, 2, v8
    s_add_u32 s6, s11, 2872
    v_add_u32 v12, s6, v12
    v_lshlrev_b32 v13, 4, v1
    v_add_u32 v13, 156544, v13
    v_add_f32 v232, v232, v17
    v_cvt_pk_bf16_f32 v65, v234, v235
    v_cvt_pk_bf16_f32 v66, v236, v237
    v_cvt_pk_bf16_f32 v67, v237, v237
    v_cvt_pk_bf16_f32 v68, v242, v242
    v_cvt_pk_bf16_f32 v64, v232, v233
    ds_write2_b32 v4, v66, v67 offset0:137 offset1:138
    ds_write_b64 v4, v[64:65] offset:32
    s_lshl_b64 exec, 1, 63
    ds_write_b32 v19, v68 offset:544
    ds_write_b16 v19, v67 offset:1060
    s_mov_b64 exec, -1
    ds_read_b128 v[72:75], v5 offset:32
    ds_read_b32 v76, v5 offset:28
    v_cvt_pk_bf16_f32 v69, v238, v239
    v_cvt_pk_bf16_f32 v70, v240, v241
    v_mov_b32 v66, v67
    ds_write_b32 v16, v69 offset:2488
    ds_write_b16 v18, v70 offset:2932
    ds_write_b16_d16_hi v18, v70 offset:3060
    s_lshl_b64 exec, 1, 63
    ds_write_b64 v19, v[66:67] offset:2272
    ds_write_b16_d16_hi v19, v69 offset:2744
    s_mov_b64 exec, -1
    v_readlane_b32 s13, v69, 63
    ds_read_b64 v[32:33], v11 offset:2368
    ds_read_b64 v[34:35], v11 offset:2376
    ds_read_b64 v[36:37], v11 offset:2432
    ds_read_b64 v[38:39], v11 offset:2440
    ds_read_b64 v[40:41], v11 offset:2496
    ds_read_b64 v[42:43], v11 offset:2504
    ds_read_b64 v[44:45], v11 offset:2560
    ds_read_b64 v[46:47], v11 offset:2568
    ds_read_b64 v[48:49], v11 offset:2624
    ds_read_b64 v[50:51], v11 offset:2632
    ds_read_b64 v[52:53], v11 offset:2688
    ds_read_b64 v[54:55], v11 offset:2696
    s_waitcnt lgkmcnt(15)
    v_alignbit_b32 v80, v72, v76, 16
    v_alignbit_b32 v81, v73, v72, 16
    v_alignbit_b32 v82, v74, v73, 16
    v_alignbit_b32 v83, v75, v74, 16
    ds_write_b128 v5, v[80:83] offset:1248
    ds_read2_b32 v[160:161], v2 offset0:0 offset1:1
    ds_read2_b32 v[162:163], v2 offset0:2 offset1:3
    ds_read2_b32 v[164:165], v2 offset0:128 offset1:129
    ds_read2_b32 v[166:167], v2 offset0:130 offset1:131
    ds_read2_b32 v[216:217], v3 offset0:0 offset1:1
    ds_read2_b32 v[218:219], v3 offset0:2 offset1:3
    v_mov_b32 v14, 160644
    s_cmp_ge_u32 s3, 4
    s_cbranch_scc1 CVW_26
    s_mov_b32 s6, 0x05040100
    s_mov_b32 s7, 0x07060302
    v_lshlrev_b32 v4, 4, v0
    v_sub_u32 v4, 123760, v4
    v_mov_b32 v15, 1
    global_load_dword v177, v178, s[38:39]
    global_load_dword v177, v179, s[38:39]
    s_waitcnt vmcnt(2)
    v_perm_b32 v96, v152, v156, s6
    v_perm_b32 v97, v144, v148, s6
    v_perm_b32 v98, v136, v140, s6
    v_perm_b32 v99, v128, v132, s6
    ds_write_b128 v4, v[96:99] offset:0
    v_perm_b32 v100, v152, v156, s7
    v_perm_b32 v101, v144, v148, s7
    v_perm_b32 v102, v136, v140, s7
    v_perm_b32 v103, v128, v132, s7
    ds_write_b128 v4, v[100:103] offset:4608
    v_perm_b32 v104, v153, v157, s6
    v_perm_b32 v105, v145, v149, s6
    v_perm_b32 v106, v137, v141, s6
    v_perm_b32 v107, v129, v133, s6
    ds_write_b128 v4, v[104:107] offset:9216
    v_perm_b32 v108, v153, v157, s7
    v_perm_b32 v109, v145, v149, s7
    v_perm_b32 v110, v137, v141, s7
    v_perm_b32 v111, v129, v133, s7
    ds_write_b128 v4, v[108:111] offset:13824
    v_perm_b32 v112, v154, v158, s6
    v_perm_b32 v113, v146, v150, s6
    v_perm_b32 v114, v138, v142, s6
    v_perm_b32 v115, v130, v134, s6
    ds_write_b128 v4, v[112:115] offset:18432
    v_perm_b32 v116, v154, v158, s7
    v_perm_b32 v117, v146, v150, s7
    v_perm_b32 v118, v138, v142, s7
    v_perm_b32 v119, v130, v134, s7
    ds_write_b128 v4, v[116:119] offset:23040
    v_perm_b32 v120, v155, v159, s6
    v_perm_b32 v121, v147, v151, s6
    v_perm_b32 v122, v139, v143, s6
    v_perm_b32 v123, v131, v135, s6
    ds_write_b128 v4, v[120:123] offset:27648
    v_perm_b32 v124, v155, v159, s7
    v_perm_b32 v125, v147, v151, s7
    v_perm_b32 v126, v139, v143, s7
    v_perm_b32 v127, v131, v135, s7
    ds_write_b128 v4, v[124:127] offset:32256
    s_waitcnt lgkmcnt(0)
    s_mov_b64 exec, 1
    ds_add_u32 v14, v15
    s_mov_b64 exec, -1
CVW_26:
    ds_read_b32 v15, v14
    s_waitcnt lgkmcnt(0)
    v_cmp_ne_u32 vcc, 4, v15
    s_cbranch_vccnz CVW_26
CVD_27:
    ds_read_b128 v[96:99], v7 offset:3584
    ds_read_b128 v[100:103], v7 offset:3072
    ds_read_b128 v[104:107], v7 offset:2560
    ds_read_b128 v[108:111], v7 offset:2048
    ds_read_b128 v[112:115], v7 offset:1536
    ds_read_b128 v[116:119], v7 offset:1024
    ds_read_b128 v[120:123], v7 offset:512
    ds_read_b128 v[124:127], v7 offset:0
    ds_read_b128 v[16:19], v13 offset:0
    ds_read_b128 v[20:23], v13 offset:1024
    ds_read_b128 v[24:27], v13 offset:2048
    ds_read_b128 v[28:31], v13 offset:3072
    ds_read_b128 v[200:203], v9 offset:256
    ds_read_b128 v[204:207], v9 offset:0
    s_waitcnt lgkmcnt(13)
    v_mfma_f32_16x16x32_bf16 v[224:227], v[160:163], v[96:99], 0
    s_lshr_b32 s13, s13, 16
    s_xor_b32 s13, s13, 0x8000
    s_waitcnt lgkmcnt(12)
    v_mfma_f32_16x16x32_bf16 v[228:231], v[160:163], v[100:103], 0
    v_and_b32 v14, 1, v6
    v_lshlrev_b32 v14, 4, v14
    s_waitcnt lgkmcnt(11)
    v_mfma_f32_16x16x32_bf16 v[232:235], v[160:163], v[104:107], 0
    ds_read_b64 v[208:209], v10 offset:1536
    v_lshlrev_b32 v14, v14, s13
    v_ashrrev_i32 v6, 1, v6
    s_waitcnt lgkmcnt(11)
    v_mfma_f32_16x16x32_bf16 v[236:239], v[160:163], v[108:111], 0
    ds_read_b64 v[210:211], v10 offset:1544
    v_cmp_eq_u32 s[84:85], 0, v6
    v_cmp_eq_u32 s[86:87], 1, v6
    s_waitcnt lgkmcnt(11)
    v_mfma_f32_16x16x32_bf16 v[240:243], v[160:163], v[112:115], 0
    ds_read_b64 v[212:213], v10 offset:0
    v_cmp_eq_u32 s[6:7], 2, v6
    v_cmp_eq_u32 vcc, 3, v6
    s_waitcnt lgkmcnt(11)
    v_mfma_f32_16x16x32_bf16 v[244:247], v[160:163], v[116:119], 0
    ds_read_b64 v[214:215], v10 offset:8
    v_cndmask_b32 v220, 0, v14, s[84:85]
    v_cndmask_b32 v221, 0, v14, s[86:87]
    s_waitcnt lgkmcnt(11)
    v_mfma_f32_16x16x32_bf16 v[248:251], v[160:163], v[120:123], 0
    ds_read2_b32 v[168:169], v2 offset0:16 offset1:17
    v_cndmask_b32 v222, 0, v14, s[6:7]
    v_cndmask_b32 v223, 0, v14, vcc
    s_waitcnt lgkmcnt(11)
    v_mfma_f32_16x16x32_bf16 v[252:255], v[160:163], v[124:127], 0
    ds_read2_b32 v[170:171], v2 offset0:18 offset1:19
    s_waitcnt lgkmcnt(7)
    v_mfma_f32_16x16x32_bf16 v[64:67], v[200:203], v[16:19], 0
    ds_read_b128 v[128:131], v7 offset:3648
    v_mfma_f32_16x16x32_bf16 v[68:71], v[200:203], v[20:23], 0
    ds_read_b128 v[132:135], v7 offset:3136
    s_waitcnt lgkmcnt(8)
    v_mfma_f32_16x16x32_bf16 v[72:75], v[204:207], v[16:19], 0
    ds_read_b128 v[136:139], v7 offset:2624
    v_mfma_f32_16x16x32_bf16 v[76:79], v[204:207], v[20:23], 0
    ds_read_b128 v[140:143], v7 offset:2112
    v_mfma_f32_16x16x32_bf16 v[228:231], v[164:167], v[96:99], v[228:231]
    ds_read_b128 v[144:147], v7 offset:1600
    v_mfma_f32_16x16x32_bf16 v[232:235], v[164:167], v[100:103], v[232:235]
    ds_read_b128 v[148:151], v7 offset:1088
    v_cvt_pk_bf16_f32 v64, v64, v68
    v_cvt_pk_bf16_f32 v65, v65, v69
    v_mfma_f32_16x16x32_bf16 v[236:239], v[164:167], v[104:107], v[236:239]
    ds_read_b128 v[152:155], v7 offset:576
    v_cvt_pk_bf16_f32 v66, v66, v70
    v_cvt_pk_bf16_f32 v67, v67, v71
    v_mfma_f32_16x16x32_bf16 v[240:243], v[164:167], v[108:111], v[240:243]
    ds_read_b128 v[156:159], v7 offset:64
    v_cvt_pk_bf16_f32 v72, v72, v76
    v_cvt_pk_bf16_f32 v73, v73, v77
    v_mfma_f32_16x16x32_bf16 v[244:247], v[164:167], v[112:115], v[244:247]
    ds_read2_b32 v[172:173], v2 offset0:144 offset1:145
    v_cvt_pk_bf16_f32 v74, v74, v78
    v_cvt_pk_bf16_f32 v75, v75, v79
    v_mfma_f32_16x16x32_bf16 v[248:251], v[164:167], v[116:119], v[248:251]
    ds_read2_b32 v[174:175], v2 offset0:146 offset1:147
    v_mfma_f32_16x16x32_bf16 v[252:255], v[164:167], v[120:123], v[252:255]
    ds_read2_b32 v[184:185], v12 offset0:0 offset1:1
    v_mfma_f32_16x16x32_bf16 v[232:235], v[216:219], v[96:99], v[232:235]
    ds_read2_b32 v[186:187], v12 offset0:2 offset1:3
    v_mfma_f32_16x16x32_bf16 v[236:239], v[216:219], v[100:103], v[236:239]
    ds_read2_b32 v[188:189], v12 offset0:16 offset1:17
    v_mfma_f32_16x16x32_bf16 v[240:243], v[216:219], v[104:107], v[240:243]
    ds_read2_b32 v[190:191], v12 offset0:18 offset1:19
    v_mfma_f32_16x16x32_bf16 v[244:247], v[216:219], v[108:111], v[244:247]
    ds_read2_b32 v[192:193], v12 offset0:32 offset1:33
    v_mfma_f32_16x16x32_bf16 v[248:251], v[216:219], v[112:115], v[248:251]
    ds_read2_b32 v[194:195], v12 offset0:34 offset1:35
    v_mfma_f32_16x16x32_bf16 v[252:255], v[216:219], v[116:119], v[252:255]
    ds_read2_b32 v[196:197], v12 offset0:48 offset1:49
    v_mfma_f32_16x16x32_bf16 v[240:243], v[220:223], v[96:99], v[240:243]
    ds_read2_b32 v[198:199], v12 offset0:50 offset1:51
    v_mfma_f32_16x16x32_bf16 v[244:247], v[220:223], v[100:103], v[244:247]
    v_mfma_f32_16x16x32_bf16 v[252:255], v[64:67], v[36:39], v[252:255]
    v_mfma_f32_16x16x32_bf16 v[248:251], v[220:223], v[104:107], v[248:251]
    v_mfma_f32_16x16x32_bf16 v[252:255], v[72:75], v[32:35], v[252:255]
    v_mfma_f32_16x16x32_bf16 v[252:255], v[220:223], v[108:111], v[252:255]
    s_waitcnt lgkmcnt(15)
    v_mfma_f32_16x16x32_bf16 v[80:83], v[208:211], v[24:27], 0
    ds_read_b64 v[200:201], v10 offset:1024
    v_mfma_f32_16x16x32_bf16 v[84:87], v[208:211], v[28:31], 0
    ds_read_b64 v[202:203], v10 offset:1032
    v_mfma_f32_16x16x32_bf16 v[88:91], v[212:215], v[24:27], 0
    ds_read_b64 v[204:205], v10 offset:512
    v_mfma_f32_16x16x32_bf16 v[92:95], v[212:215], v[28:31], 0
    ds_read_b64 v[206:207], v10 offset:520
    v_mfma_f32_16x16x32_bf16 v[224:227], v[168:171], v[128:131], v[224:227]
    ds_read2_b32 v[160:161], v2 offset0:32 offset1:33
    v_mfma_f32_16x16x32_bf16 v[228:231], v[168:171], v[132:135], v[228:231]
    ds_read2_b32 v[162:163], v2 offset0:34 offset1:35
    v_cvt_pk_bf16_f32 v80, v80, v84
    v_cvt_pk_bf16_f32 v81, v81, v85
    v_mfma_f32_16x16x32_bf16 v[232:235], v[168:171], v[136:139], v[232:235]
    ds_read_b128 v[96:99], v7 offset:3712
    v_cvt_pk_bf16_f32 v82, v82, v86
    v_cvt_pk_bf16_f32 v83, v83, v87
    s_waitcnt lgkmcnt(15)
    v_mfma_f32_16x16x32_bf16 v[236:239], v[168:171], v[140:143], v[236:239]
    ds_read_b128 v[100:103], v7 offset:3200
    v_cvt_pk_bf16_f32 v88, v88, v92
    v_cvt_pk_bf16_f32 v89, v89, v93
    v_mfma_f32_16x16x32_bf16 v[240:243], v[168:171], v[144:147], v[240:243]
    ds_read_b128 v[104:107], v7 offset:2688
    v_cvt_pk_bf16_f32 v90, v90, v94
    v_cvt_pk_bf16_f32 v91, v91, v95
    v_mfma_f32_16x16x32_bf16 v[244:247], v[168:171], v[148:151], v[244:247]
    ds_read_b128 v[108:111], v7 offset:2176
    v_mfma_f32_16x16x32_bf16 v[248:251], v[168:171], v[152:155], v[248:251]
    ds_read_b128 v[112:115], v7 offset:1664
    v_mfma_f32_16x16x32_bf16 v[252:255], v[168:171], v[156:159], v[252:255]
    ds_read_b128 v[116:119], v7 offset:1152
    v_mfma_f32_16x16x32_bf16 v[228:231], v[172:175], v[128:131], v[228:231]
    ds_read_b128 v[120:123], v7 offset:640
    v_mfma_f32_16x16x32_bf16 v[232:235], v[172:175], v[132:135], v[232:235]
    ds_read_b128 v[124:127], v7 offset:128
    s_waitcnt lgkmcnt(15)
    v_mfma_f32_16x16x32_bf16 v[240:243], v[80:83], v[184:187], v[240:243]
    ds_read2_b32 v[164:165], v2 offset0:160 offset1:161
    v_mfma_f32_16x16x32_bf16 v[236:239], v[172:175], v[136:139], v[236:239]
    ds_read2_b32 v[166:167], v2 offset0:162 offset1:163
    v_mfma_f32_16x16x32_bf16 v[252:255], v[88:91], v[184:187], v[252:255]
    v_mfma_f32_16x16x32_bf16 v[240:243], v[172:175], v[140:143], v[240:243]
    v_mfma_f32_16x16x32_bf16 v[244:247], v[80:83], v[188:191], v[244:247]
    v_mfma_f32_16x16x32_bf16 v[244:247], v[172:175], v[144:147], v[244:247]
    v_mfma_f32_16x16x32_bf16 v[248:251], v[80:83], v[192:195], v[248:251]
    v_mfma_f32_16x16x32_bf16 v[248:251], v[172:175], v[148:151], v[248:251]
    s_waitcnt lgkmcnt(15)
    v_mfma_f32_16x16x32_bf16 v[252:255], v[80:83], v[196:199], v[252:255]
    v_mfma_f32_16x16x32_bf16 v[252:255], v[172:175], v[152:155], v[252:255]
    s_waitcnt lgkmcnt(14)
    v_mfma_f32_16x16x32_bf16 v[64:67], v[200:203], v[24:27], 0
    ds_read_b128 v[208:211], v9 offset:768
    v_mfma_f32_16x16x32_bf16 v[68:71], v[200:203], v[28:31], 0
    ds_read_b128 v[212:215], v9 offset:512
    s_waitcnt lgkmcnt(14)
    v_mfma_f32_16x16x32_bf16 v[72:75], v[204:207], v[24:27], 0
    ds_read2_b32 v[168:169], v2 offset0:48 offset1:49
    v_mfma_f32_16x16x32_bf16 v[76:79], v[204:207], v[28:31], 0
    ds_read2_b32 v[170:171], v2 offset0:50 offset1:51
    s_waitcnt lgkmcnt(13)
    v_mfma_f32_16x16x32_bf16 v[224:227], v[160:163], v[96:99], v[224:227]
    ds_read_b128 v[128:131], v7 offset:3776
    s_waitcnt lgkmcnt(13)
    v_mfma_f32_16x16x32_bf16 v[228:231], v[160:163], v[100:103], v[228:231]
    ds_read_b128 v[132:135], v7 offset:3264
    v_cvt_pk_bf16_f32 v64, v64, v68
    v_cvt_pk_bf16_f32 v65, v65, v69
    s_waitcnt lgkmcnt(13)
    v_mfma_f32_16x16x32_bf16 v[232:235], v[160:163], v[104:107], v[232:235]
    ds_read_b128 v[136:139], v7 offset:2752
    v_cvt_pk_bf16_f32 v66, v66, v70
    v_cvt_pk_bf16_f32 v67, v67, v71
    s_waitcnt lgkmcnt(13)
    v_mfma_f32_16x16x32_bf16 v[236:239], v[160:163], v[108:111], v[236:239]
    ds_read_b128 v[140:143], v7 offset:2240
    v_cvt_pk_bf16_f32 v72, v72, v76
    v_cvt_pk_bf16_f32 v73, v73, v77
    s_waitcnt lgkmcnt(13)
    v_mfma_f32_16x16x32_bf16 v[240:243], v[160:163], v[112:115], v[240:243]
    ds_read_b128 v[144:147], v7 offset:1728
    v_cvt_pk_bf16_f32 v74, v74, v78
    v_cvt_pk_bf16_f32 v75, v75, v79
    s_waitcnt lgkmcnt(13)
    v_mfma_f32_16x16x32_bf16 v[244:247], v[160:163], v[116:119], v[244:247]
    ds_read_b128 v[148:151], v7 offset:1216
    s_waitcnt lgkmcnt(13)
    v_mfma_f32_16x16x32_bf16 v[248:251], v[160:163], v[120:123], v[248:251]
    ds_read_b128 v[152:155], v7 offset:704
    s_waitcnt lgkmcnt(13)
    v_mfma_f32_16x16x32_bf16 v[252:255], v[160:163], v[124:127], v[252:255]
    ds_read_b128 v[156:159], v7 offset:192
    s_waitcnt lgkmcnt(12)
    v_mfma_f32_16x16x32_bf16 v[228:231], v[164:167], v[96:99], v[228:231]
    ds_read2_b32 v[172:173], v2 offset0:176 offset1:177
    v_mfma_f32_16x16x32_bf16 v[232:235], v[164:167], v[100:103], v[232:235]
    ds_read2_b32 v[174:175], v2 offset0:178 offset1:179
    v_mfma_f32_16x16x32_bf16 v[244:247], v[64:67], v[184:187], v[244:247]
    v_mfma_f32_16x16x32_bf16 v[236:239], v[164:167], v[104:107], v[236:239]
    v_mfma_f32_16x16x32_bf16 v[252:255], v[72:75], v[188:191], v[252:255]
    v_mfma_f32_16x16x32_bf16 v[240:243], v[164:167], v[108:111], v[240:243]
    v_mfma_f32_16x16x32_bf16 v[248:251], v[64:67], v[188:191], v[248:251]
    v_mfma_f32_16x16x32_bf16 v[244:247], v[164:167], v[112:115], v[244:247]
    v_mfma_f32_16x16x32_bf16 v[248:251], v[72:75], v[184:187], v[248:251]
    v_mfma_f32_16x16x32_bf16 v[248:251], v[164:167], v[116:119], v[248:251]
    v_mfma_f32_16x16x32_bf16 v[252:255], v[64:67], v[192:195], v[252:255]
    v_mfma_f32_16x16x32_bf16 v[252:255], v[164:167], v[120:123], v[252:255]
    s_waitcnt lgkmcnt(13)
    v_mfma_f32_16x16x32_bf16 v[80:83], v[208:211], v[16:19], 0
    ds_read_b128 v[200:203], v9 offset:2816
    v_mfma_f32_16x16x32_bf16 v[84:87], v[208:211], v[20:23], 0
    ds_read_b128 v[204:207], v9 offset:2560
    s_waitcnt lgkmcnt(14)
    v_mfma_f32_16x16x32_bf16 v[88:91], v[212:215], v[16:19], 0
    ds_read2_b32 v[160:161], v2 offset0:64 offset1:65
    v_mfma_f32_16x16x32_bf16 v[92:95], v[212:215], v[20:23], 0
    ds_read2_b32 v[162:163], v2 offset0:66 offset1:67
    s_waitcnt lgkmcnt(13)
    v_mfma_f32_16x16x32_bf16 v[224:227], v[168:171], v[128:131], v[224:227]
    ds_read_b128 v[96:99], v7 offset:3840
    s_waitcnt lgkmcnt(13)
    v_mfma_f32_16x16x32_bf16 v[228:231], v[168:171], v[132:135], v[228:231]
    ds_read_b128 v[100:103], v7 offset:3328
    v_cvt_pk_bf16_f32 v80, v80, v84
    v_cvt_pk_bf16_f32 v81, v81, v85
    s_waitcnt lgkmcnt(13)
    v_mfma_f32_16x16x32_bf16 v[232:235], v[168:171], v[136:139], v[232:235]
    ds_read_b128 v[104:107], v7 offset:2816
    v_cvt_pk_bf16_f32 v82, v82, v86
    v_cvt_pk_bf16_f32 v83, v83, v87
    s_waitcnt lgkmcnt(13)
    v_mfma_f32_16x16x32_bf16 v[236:239], v[168:171], v[140:143], v[236:239]
    ds_read_b128 v[108:111], v7 offset:2304
    v_cvt_pk_bf16_f32 v88, v88, v92
    v_cvt_pk_bf16_f32 v89, v89, v93
    s_waitcnt lgkmcnt(13)
    v_mfma_f32_16x16x32_bf16 v[240:243], v[168:171], v[144:147], v[240:243]
    ds_read_b128 v[112:115], v7 offset:1792
    v_cvt_pk_bf16_f32 v90, v90, v94
    v_cvt_pk_bf16_f32 v91, v91, v95
    s_waitcnt lgkmcnt(13)
    v_mfma_f32_16x16x32_bf16 v[244:247], v[168:171], v[148:151], v[244:247]
    ds_read_b128 v[116:119], v7 offset:1280
    s_waitcnt lgkmcnt(13)
    v_mfma_f32_16x16x32_bf16 v[248:251], v[168:171], v[152:155], v[248:251]
    ds_read_b128 v[120:123], v7 offset:768
    s_waitcnt lgkmcnt(13)
    v_mfma_f32_16x16x32_bf16 v[252:255], v[168:171], v[156:159], v[252:255]
    ds_read_b128 v[124:127], v7 offset:256
    s_waitcnt lgkmcnt(12)
    v_mfma_f32_16x16x32_bf16 v[228:231], v[172:175], v[128:131], v[228:231]
    ds_read2_b32 v[164:165], v2 offset0:192 offset1:193
    v_mfma_f32_16x16x32_bf16 v[232:235], v[172:175], v[132:135], v[232:235]
    ds_read2_b32 v[166:167], v2 offset0:194 offset1:195
    v_mfma_f32_16x16x32_bf16 v[236:239], v[172:175], v[136:139], v[236:239]
    v_mfma_f32_16x16x32_bf16 v[248:251], v[80:83], v[36:39], v[248:251]
    v_mfma_f32_16x16x32_bf16 v[240:243], v[172:175], v[140:143], v[240:243]
    v_mfma_f32_16x16x32_bf16 v[252:255], v[88:91], v[40:43], v[252:255]
    v_mfma_f32_16x16x32_bf16 v[244:247], v[172:175], v[144:147], v[244:247]
    v_mfma_f32_16x16x32_bf16 v[252:255], v[80:83], v[44:47], v[252:255]
    v_mfma_f32_16x16x32_bf16 v[248:251], v[172:175], v[148:151], v[248:251]
    v_mfma_f32_16x16x32_bf16 v[248:251], v[88:91], v[32:35], v[248:251]
    v_mfma_f32_16x16x32_bf16 v[252:255], v[172:175], v[152:155], v[252:255]
    s_waitcnt lgkmcnt(13)
    v_mfma_f32_16x16x32_bf16 v[64:67], v[200:203], v[16:19], 0
    ds_read_b128 v[208:211], v9 offset:2304
    v_mfma_f32_16x16x32_bf16 v[68:71], v[200:203], v[20:23], 0
    ds_read_b128 v[212:215], v9 offset:2048
    s_waitcnt lgkmcnt(14)
    v_mfma_f32_16x16x32_bf16 v[72:75], v[204:207], v[16:19], 0
    ds_read2_b32 v[168:169], v2 offset0:80 offset1:81
    v_mfma_f32_16x16x32_bf16 v[76:79], v[204:207], v[20:23], 0
    ds_read2_b32 v[170:171], v2 offset0:82 offset1:83
    s_waitcnt lgkmcnt(13)
    v_mfma_f32_16x16x32_bf16 v[224:227], v[160:163], v[96:99], v[224:227]
    ds_read_b128 v[128:131], v7 offset:3904
    s_waitcnt lgkmcnt(13)
    v_mfma_f32_16x16x32_bf16 v[228:231], v[160:163], v[100:103], v[228:231]
    ds_read_b128 v[132:135], v7 offset:3392
    v_cvt_pk_bf16_f32 v64, v64, v68
    v_cvt_pk_bf16_f32 v65, v65, v69
    s_waitcnt lgkmcnt(13)
    v_mfma_f32_16x16x32_bf16 v[232:235], v[160:163], v[104:107], v[232:235]
    ds_read_b128 v[136:139], v7 offset:2880
    v_cvt_pk_bf16_f32 v66, v66, v70
    v_cvt_pk_bf16_f32 v67, v67, v71
    s_waitcnt lgkmcnt(13)
    v_mfma_f32_16x16x32_bf16 v[236:239], v[160:163], v[108:111], v[236:239]
    ds_read_b128 v[140:143], v7 offset:2368
    v_cvt_pk_bf16_f32 v72, v72, v76
    v_cvt_pk_bf16_f32 v73, v73, v77
    s_waitcnt lgkmcnt(13)
    v_mfma_f32_16x16x32_bf16 v[240:243], v[160:163], v[112:115], v[240:243]
    ds_read_b128 v[144:147], v7 offset:1856
    v_cvt_pk_bf16_f32 v74, v74, v78
    v_cvt_pk_bf16_f32 v75, v75, v79
    s_waitcnt lgkmcnt(13)
    v_mfma_f32_16x16x32_bf16 v[244:247], v[160:163], v[116:119], v[244:247]
    ds_read_b128 v[148:151], v7 offset:1344
    s_waitcnt lgkmcnt(13)
    v_mfma_f32_16x16x32_bf16 v[248:251], v[160:163], v[120:123], v[248:251]
    ds_read_b128 v[152:155], v7 offset:832
    s_waitcnt lgkmcnt(13)
    v_mfma_f32_16x16x32_bf16 v[252:255], v[160:163], v[124:127], v[252:255]
    ds_read_b128 v[156:159], v7 offset:320
    s_waitcnt lgkmcnt(12)
    v_mfma_f32_16x16x32_bf16 v[228:231], v[164:167], v[96:99], v[228:231]
    ds_read2_b32 v[172:173], v2 offset0:208 offset1:209
    v_mfma_f32_16x16x32_bf16 v[232:235], v[64:67], v[36:39], v[232:235]
    ds_read2_b32 v[174:175], v2 offset0:210 offset1:211
    v_mfma_f32_16x16x32_bf16 v[232:235], v[164:167], v[100:103], v[232:235]
    v_mfma_f32_16x16x32_bf16 v[240:243], v[72:75], v[48:51], v[240:243]
    v_mfma_f32_16x16x32_bf16 v[236:239], v[164:167], v[104:107], v[236:239]
    v_mfma_f32_16x16x32_bf16 v[236:239], v[64:67], v[44:47], v[236:239]
    v_mfma_f32_16x16x32_bf16 v[240:243], v[164:167], v[108:111], v[240:243]
    v_mfma_f32_16x16x32_bf16 v[236:239], v[72:75], v[40:43], v[236:239]
    v_mfma_f32_16x16x32_bf16 v[244:247], v[164:167], v[112:115], v[244:247]
    v_mfma_f32_16x16x32_bf16 v[240:243], v[64:67], v[52:55], v[240:243]
    v_mfma_f32_16x16x32_bf16 v[248:251], v[164:167], v[116:119], v[248:251]
    v_mfma_f32_16x16x32_bf16 v[232:235], v[72:75], v[32:35], v[232:235]
    v_mfma_f32_16x16x32_bf16 v[252:255], v[164:167], v[120:123], v[252:255]
    s_waitcnt lgkmcnt(13)
    v_mfma_f32_16x16x32_bf16 v[80:83], v[208:211], v[16:19], 0
    ds_read_b128 v[200:203], v9 offset:1792
    v_mfma_f32_16x16x32_bf16 v[84:87], v[208:211], v[20:23], 0
    ds_read_b128 v[204:207], v9 offset:1536
    s_waitcnt lgkmcnt(14)
    v_mfma_f32_16x16x32_bf16 v[88:91], v[212:215], v[16:19], 0
    ds_read2_b32 v[160:161], v2 offset0:96 offset1:97
    v_mfma_f32_16x16x32_bf16 v[92:95], v[212:215], v[20:23], 0
    ds_read2_b32 v[162:163], v2 offset0:98 offset1:99
    s_waitcnt lgkmcnt(13)
    v_mfma_f32_16x16x32_bf16 v[224:227], v[168:171], v[128:131], v[224:227]
    ds_read_b128 v[96:99], v7 offset:3968
    s_waitcnt lgkmcnt(13)
    v_mfma_f32_16x16x32_bf16 v[228:231], v[168:171], v[132:135], v[228:231]
    ds_read_b128 v[100:103], v7 offset:3456
    v_cvt_pk_bf16_f32 v80, v80, v84
    v_cvt_pk_bf16_f32 v81, v81, v85
    s_waitcnt lgkmcnt(13)
    v_mfma_f32_16x16x32_bf16 v[232:235], v[168:171], v[136:139], v[232:235]
    ds_read_b128 v[104:107], v7 offset:2944
    v_cvt_pk_bf16_f32 v82, v82, v86
    v_cvt_pk_bf16_f32 v83, v83, v87
    s_waitcnt lgkmcnt(13)
    v_mfma_f32_16x16x32_bf16 v[236:239], v[168:171], v[140:143], v[236:239]
    ds_read_b128 v[108:111], v7 offset:2432
    v_cvt_pk_bf16_f32 v88, v88, v92
    v_cvt_pk_bf16_f32 v89, v89, v93
    s_waitcnt lgkmcnt(13)
    v_mfma_f32_16x16x32_bf16 v[240:243], v[168:171], v[144:147], v[240:243]
    ds_read_b128 v[112:115], v7 offset:1920
    v_cvt_pk_bf16_f32 v90, v90, v94
    v_cvt_pk_bf16_f32 v91, v91, v95
    s_waitcnt lgkmcnt(13)
    v_mfma_f32_16x16x32_bf16 v[244:247], v[168:171], v[148:151], v[244:247]
    ds_read_b128 v[116:119], v7 offset:1408
    s_waitcnt lgkmcnt(13)
    v_mfma_f32_16x16x32_bf16 v[248:251], v[168:171], v[152:155], v[248:251]
    ds_read_b128 v[120:123], v7 offset:896
    s_waitcnt lgkmcnt(13)
    v_mfma_f32_16x16x32_bf16 v[252:255], v[168:171], v[156:159], v[252:255]
    ds_read_b128 v[124:127], v7 offset:384
    s_waitcnt lgkmcnt(12)
    v_mfma_f32_16x16x32_bf16 v[228:231], v[172:175], v[128:131], v[228:231]
    ds_read2_b32 v[164:165], v2 offset0:224 offset1:225
    v_mfma_f32_16x16x32_bf16 v[236:239], v[80:83], v[36:39], v[236:239]
    ds_read2_b32 v[166:167], v2 offset0:226 offset1:227
    v_mfma_f32_16x16x32_bf16 v[232:235], v[172:175], v[132:135], v[232:235]
    v_mfma_f32_16x16x32_bf16 v[244:247], v[88:91], v[48:51], v[244:247]
    v_mfma_f32_16x16x32_bf16 v[236:239], v[172:175], v[136:139], v[236:239]
    v_mfma_f32_16x16x32_bf16 v[240:243], v[80:83], v[44:47], v[240:243]
    v_mfma_f32_16x16x32_bf16 v[240:243], v[172:175], v[140:143], v[240:243]
    v_mfma_f32_16x16x32_bf16 v[240:243], v[88:91], v[40:43], v[240:243]
    v_mfma_f32_16x16x32_bf16 v[244:247], v[172:175], v[144:147], v[244:247]
    v_mfma_f32_16x16x32_bf16 v[244:247], v[80:83], v[52:55], v[244:247]
    v_mfma_f32_16x16x32_bf16 v[248:251], v[172:175], v[148:151], v[248:251]
    v_mfma_f32_16x16x32_bf16 v[236:239], v[88:91], v[32:35], v[236:239]
    v_mfma_f32_16x16x32_bf16 v[252:255], v[172:175], v[152:155], v[252:255]
    v_mov_b32 v6, 0
    buffer_load_dword v14, v6, s[76:79], 0 offen sc1
    v_and_b32 v15, 15, v1
    v_lshlrev_b32 v15, 5, v15
    v_bfe_u32 v8, v1, 4, 1
    v_lshl_add_u32 v15, v8, 9, v15
    v_lshrrev_b32 v8, 5, v1
    v_lshl_add_u32 v15, v8, 4, v15
    s_mul_i32 s6, s9, 4096
    v_add_u32 v15, s6, v15
    s_waitcnt lgkmcnt(13)
    v_mfma_f32_16x16x32_bf16 v[64:67], v[200:203], v[16:19], 0
    ds_read_b128 v[208:211], v9 offset:1280
    v_mfma_f32_16x16x32_bf16 v[68:71], v[200:203], v[20:23], 0
    ds_read_b128 v[212:215], v9 offset:1024
    s_waitcnt lgkmcnt(14)
    v_mfma_f32_16x16x32_bf16 v[72:75], v[204:207], v[16:19], 0
    ds_read2_b32 v[168:169], v2 offset0:112 offset1:113
    v_mfma_f32_16x16x32_bf16 v[76:79], v[204:207], v[20:23], 0
    ds_read2_b32 v[170:171], v2 offset0:114 offset1:115
    s_waitcnt lgkmcnt(13)
    v_mfma_f32_16x16x32_bf16 v[224:227], v[160:163], v[96:99], v[224:227]
    ds_read_b128 v[128:131], v7 offset:4032
    s_waitcnt lgkmcnt(13)
    v_mfma_f32_16x16x32_bf16 v[228:231], v[160:163], v[100:103], v[228:231]
    ds_read_b128 v[132:135], v7 offset:3520
    v_cvt_pk_bf16_f32 v64, v64, v68
    v_cvt_pk_bf16_f32 v65, v65, v69
    s_waitcnt lgkmcnt(13)
    v_mfma_f32_16x16x32_bf16 v[232:235], v[160:163], v[104:107], v[232:235]
    ds_read_b128 v[136:139], v7 offset:3008
    v_cvt_pk_bf16_f32 v66, v66, v70
    v_cvt_pk_bf16_f32 v67, v67, v71
    s_waitcnt lgkmcnt(13)
    v_mfma_f32_16x16x32_bf16 v[236:239], v[160:163], v[108:111], v[236:239]
    ds_read_b128 v[140:143], v7 offset:2496
    v_cvt_pk_bf16_f32 v72, v72, v76
    v_cvt_pk_bf16_f32 v73, v73, v77
    s_waitcnt lgkmcnt(13)
    v_mfma_f32_16x16x32_bf16 v[240:243], v[160:163], v[112:115], v[240:243]
    ds_read_b128 v[144:147], v7 offset:1984
    v_cvt_pk_bf16_f32 v74, v74, v78
    v_cvt_pk_bf16_f32 v75, v75, v79
    s_waitcnt lgkmcnt(13)
    v_mfma_f32_16x16x32_bf16 v[244:247], v[160:163], v[116:119], v[244:247]
    ds_read_b128 v[148:151], v7 offset:1472
    s_waitcnt lgkmcnt(13)
    v_mfma_f32_16x16x32_bf16 v[248:251], v[160:163], v[120:123], v[248:251]
    ds_read_b128 v[152:155], v7 offset:960
    s_waitcnt lgkmcnt(13)
    v_mfma_f32_16x16x32_bf16 v[252:255], v[160:163], v[124:127], v[252:255]
    ds_read_b128 v[156:159], v7 offset:448
    s_waitcnt lgkmcnt(12)
    v_mfma_f32_16x16x32_bf16 v[228:231], v[164:167], v[96:99], v[228:231]
    ds_read2_b32 v[172:173], v2 offset0:240 offset1:241
    v_mfma_f32_16x16x32_bf16 v[240:243], v[64:67], v[36:39], v[240:243]
    ds_read2_b32 v[174:175], v2 offset0:242 offset1:243
    v_mfma_f32_16x16x32_bf16 v[232:235], v[164:167], v[100:103], v[232:235]
    v_mfma_f32_16x16x32_bf16 v[248:251], v[72:75], v[48:51], v[248:251]
    v_mfma_f32_16x16x32_bf16 v[236:239], v[164:167], v[104:107], v[236:239]
    v_mfma_f32_16x16x32_bf16 v[244:247], v[64:67], v[44:47], v[244:247]
    v_mfma_f32_16x16x32_bf16 v[240:243], v[164:167], v[108:111], v[240:243]
    v_mfma_f32_16x16x32_bf16 v[244:247], v[72:75], v[40:43], v[244:247]
    v_mfma_f32_16x16x32_bf16 v[244:247], v[164:167], v[112:115], v[244:247]
    v_mfma_f32_16x16x32_bf16 v[248:251], v[64:67], v[52:55], v[248:251]
    v_mfma_f32_16x16x32_bf16 v[248:251], v[164:167], v[116:119], v[248:251]
    v_mfma_f32_16x16x32_bf16 v[240:243], v[72:75], v[32:35], v[240:243]
    v_mfma_f32_16x16x32_bf16 v[252:255], v[164:167], v[120:123], v[252:255]
    s_waitcnt lgkmcnt(13)
    v_mfma_f32_16x16x32_bf16 v[80:83], v[208:211], v[16:19], 0
    v_mfma_f32_16x16x32_bf16 v[84:87], v[208:211], v[20:23], 0
    s_waitcnt lgkmcnt(12)
    v_mfma_f32_16x16x32_bf16 v[88:91], v[212:215], v[16:19], 0
    v_mfma_f32_16x16x32_bf16 v[92:95], v[212:215], v[20:23], 0
    s_waitcnt lgkmcnt(9)
    v_mfma_f32_16x16x32_bf16 v[224:227], v[168:171], v[128:131], v[224:227]
    s_waitcnt lgkmcnt(8)
    v_mfma_f32_16x16x32_bf16 v[228:231], v[168:171], v[132:135], v[228:231]
    s_nop 0
    v_cvt_pk_bf16_f32 v80, v80, v84
    v_cvt_pk_bf16_f32 v81, v81, v85
    s_waitcnt lgkmcnt(7)
    v_mfma_f32_16x16x32_bf16 v[232:235], v[168:171], v[136:139], v[232:235]
    v_cvt_pk_bf16_f32 v82, v82, v86
    v_cvt_pk_bf16_f32 v83, v83, v87
    s_waitcnt lgkmcnt(6)
    v_mfma_f32_16x16x32_bf16 v[236:239], v[168:171], v[140:143], v[236:239]
    v_cvt_pk_bf16_f32 v88, v88, v92
    v_cvt_pk_bf16_f32 v89, v89, v93
    s_waitcnt lgkmcnt(5)
    v_mfma_f32_16x16x32_bf16 v[240:243], v[168:171], v[144:147], v[240:243]
    v_cvt_pk_bf16_f32 v90, v90, v94
    v_cvt_pk_bf16_f32 v91, v91, v95
    s_waitcnt lgkmcnt(4)
    v_mfma_f32_16x16x32_bf16 v[244:247], v[168:171], v[148:151], v[244:247]
    s_waitcnt lgkmcnt(3)
    v_mfma_f32_16x16x32_bf16 v[248:251], v[168:171], v[152:155], v[248:251]
    s_waitcnt lgkmcnt(2)
    v_mfma_f32_16x16x32_bf16 v[252:255], v[168:171], v[156:159], v[252:255]
    s_waitcnt lgkmcnt(0)
    v_mfma_f32_16x16x32_bf16 v[228:231], v[172:175], v[128:131], v[228:231]
    v_mfma_f32_16x16x32_bf16 v[244:247], v[80:83], v[36:39], v[244:247]
    v_mfma_f32_16x16x32_bf16 v[232:235], v[172:175], v[132:135], v[232:235]
    v_mfma_f32_16x16x32_bf16 v[252:255], v[88:91], v[48:51], v[252:255]
    v_mfma_f32_16x16x32_bf16 v[236:239], v[172:175], v[136:139], v[236:239]
    v_mfma_f32_16x16x32_bf16 v[248:251], v[80:83], v[44:47], v[248:251]
    v_mfma_f32_16x16x32_bf16 v[240:243], v[172:175], v[140:143], v[240:243]
    v_mfma_f32_16x16x32_bf16 v[248:251], v[88:91], v[40:43], v[248:251]
    v_mfma_f32_16x16x32_bf16 v[244:247], v[172:175], v[144:147], v[244:247]
    v_mfma_f32_16x16x32_bf16 v[252:255], v[80:83], v[52:55], v[252:255]
    v_mfma_f32_16x16x32_bf16 v[248:251], v[172:175], v[148:151], v[248:251]
    v_mfma_f32_16x16x32_bf16 v[244:247], v[88:91], v[32:35], v[244:247]
    v_mfma_f32_16x16x32_bf16 v[252:255], v[172:175], v[152:155], v[252:255]
    v_cvt_pk_bf16_f32 v96, v224, v225
    v_cvt_pk_bf16_f32 v97, v226, v227
    v_cvt_pk_bf16_f32 v98, v228, v229
    v_cvt_pk_bf16_f32 v99, v230, v231
    v_cvt_pk_bf16_f32 v100, v232, v233
    v_cvt_pk_bf16_f32 v101, v234, v235
    v_cvt_pk_bf16_f32 v102, v236, v237
    v_cvt_pk_bf16_f32 v103, v238, v239
    v_cvt_pk_bf16_f32 v104, v240, v241
    v_cvt_pk_bf16_f32 v105, v242, v243
    v_cvt_pk_bf16_f32 v106, v244, v245
    v_cvt_pk_bf16_f32 v107, v246, v247
    v_cvt_pk_bf16_f32 v108, v248, v249
    v_cvt_pk_bf16_f32 v109, v250, v251
    v_cvt_pk_bf16_f32 v110, v252, v253
    v_cvt_pk_bf16_f32 v111, v254, v255
    v_permlane16_swap_b32 v96, v98
    v_permlane16_swap_b32 v97, v99
    buffer_store_dwordx4 v[96:99], v15, s[64:67], 0 offen offset:0 sc1
    v_permlane16_swap_b32 v100, v102
    v_permlane16_swap_b32 v101, v103
    buffer_store_dwordx4 v[100:103], v15, s[64:67], 0 offen offset:1024 sc1
    v_permlane16_swap_b32 v104, v106
    v_permlane16_swap_b32 v105, v107
    buffer_store_dwordx4 v[104:107], v15, s[64:67], 0 offen offset:2048 sc1
    v_permlane16_swap_b32 v108, v110
    v_permlane16_swap_b32 v109, v111
    buffer_store_dwordx4 v[108:111], v15, s[64:67], 0 offen offset:3072 sc1
    v_mov_b32 v8, 160640
    v_mov_b32 v9, 1
    s_waitcnt vmcnt(0)
    v_cmp_eq_u32 vcc, 1, v14
    s_cbranch_vccnz RDYD_30
RDY_29:
    buffer_load_dword v14, v6, s[76:79], 0 offen sc1
    s_waitcnt vmcnt(0)
    v_cmp_eq_u32 vcc, 1, v14
    s_cbranch_vccz RDY_29
RDYD_30:
    s_mov_b64 exec, 1
    ds_add_rtn_u32 v9, v8, v9
    s_mov_b64 exec, -1
    s_waitcnt lgkmcnt(0)
    v_readfirstlane_b32 s6, v9
    s_nop 0
    s_cmp_lg_u32 s6, 7
    s_cbranch_scc1 CVE_28
    s_lshr_b32 s6, s8, 3
    s_mul_i32 s6, s6, 96
    s_lshl_b32 s8, s8, 2
    s_add_u32 s6, s6, s8
    s_add_u32 s6, s6, 40960
    s_add_u32 s7, s6, 0x4000
    v_mov_b32 v9, s7
    v_mov_b32 v8, 1
    s_mov_b64 exec, 1
    buffer_store_dword v8, v9, s[68:71], 0 offen sc1
    s_mov_b64 exec, -1
CVE_28:
L_END:
    s_endpgm
.section .rodata,"a"
.p2align 6
.amdhsa_kernel gated_mix__ssm_conv_s4__dense_activation_relu__prompt_kernel
  .amdhsa_next_free_vgpr 256
  .amdhsa_next_free_sgpr 102
  .amdhsa_accum_offset 256
  .amdhsa_group_segment_fixed_size 0
  .amdhsa_kernarg_size 128
  .amdhsa_user_sgpr_count 2
  .amdhsa_user_sgpr_kernarg_segment_ptr 1
  .amdhsa_system_sgpr_workgroup_id_x 1
.end_amdhsa_kernel
```
